```python
import torch

def _softmax(x, axis=-1):
    return torch.softmax(x, dim=axis)
def _gelu(x):
    return torch.nn.functional.gelu(x, approximate="tanh")
def _silu(x):
    return torch.nn.functional.silu(x)
def _sigmoid(x):
    return torch.sigmoid(x)
def _layernorm(x, axis=-1, eps=1e-5):
    m = x.mean(dim=axis, keepdim=True)
    v = x.var(dim=axis, keepdim=True, unbiased=False)
    return (x - m) / torch.sqrt(v + eps)
def _scatter_add(tgt, idx, src, axis=0):
    return tgt.clone().index_add_(axis, idx, src)
def _segment_sum(src, seg, n):
    out = torch.zeros((n,) + src.shape[1:], dtype=src.dtype)
    return out.index_add_(0, seg, src)
def _pad(x, pw):
    flat = tuple(v for pair in reversed(pw) for v in pair)
    return torch.nn.functional.pad(x, flat)

kernel_name = 'parallel_sum__ssm_conv_s4__dense_activation_relu__prompt'

def setup_inputs():

    _w = (lambda a: (lambda t: t.to(torch.bfloat16) if t.is_floating_point() else t)(torch.as_tensor(a)))
    def _A_setup():
        B, L, D, N = 1, 2048, 448, 256
        A_re = -(lambda _x: torch.exp(torch.as_tensor(_x)))((lambda *s: torch.randn(*s, dtype=torch.bfloat16) * 6.4)(D, N))
        A_im = torch.pi * (lambda *s: torch.randn(*s, dtype=torch.bfloat16) * 0.1)(D, N)
        B_re = (lambda *s: torch.randn(*s, dtype=torch.bfloat16) * 0.2)(D, N)
        B_im = (lambda *s: torch.randn(*s, dtype=torch.bfloat16) * 0.2)(D, N)
        C_re = (lambda *s: torch.randn(*s, dtype=torch.bfloat16) * 0.2)(D, N)
        C_im = (lambda *s: torch.randn(*s, dtype=torch.bfloat16) * 0.2)(D, N)
        log_dt = (lambda *s: torch.randn(*s, dtype=torch.bfloat16) * 0.1)(D) * 0.5 - 4.0
        Dskip = (lambda *s: torch.randn(*s, dtype=torch.bfloat16) * 0.1)(D)
        return {
            "u": _w((lambda *s: torch.randn(*s, dtype=torch.bfloat16) * 0.05)(B, L, D)),
            "A_re": _w(A_re),
            "A_im": _w(A_im),
            "B_re": _w(B_re),
            "B_im": _w(B_im),
            "C_re": _w(C_re),
            "C_im": _w(C_im),
            "log_dt": _w(log_dt),
            "Dskip": _w(Dskip),
        }
    _A_in = _A_setup()

    def _B_setup():
        B, S, D, Dff = 1, 2048, 448, 1792
        return {
            "x": _w((lambda *s: torch.randn(*s, dtype=torch.bfloat16) * 0.05)(B, S, D)),
            "w1": _w((lambda *s: torch.randn(*s, dtype=torch.bfloat16) * 0.05)(D, Dff)),
            "w2": _w((lambda *s: torch.randn(*s, dtype=torch.bfloat16) * 0.05)(Dff, D)),
        }
    _B_in = _B_setup()

    return {
        "A_u": _A_in["u"],
        "A_A_re": _A_in["A_re"],
        "A_A_im": _A_in["A_im"],
        "A_B_re": _A_in["B_re"],
        "A_B_im": _A_in["B_im"],
        "A_C_re": _A_in["C_re"],
        "A_C_im": _A_in["C_im"],
        "A_log_dt": _A_in["log_dt"],
        "A_Dskip": _A_in["Dskip"],
        "B_x": _B_in["x"],
        "B_w1": _B_in["w1"],
        "B_w2": _B_in["w2"],
    }

def reference(A_u, A_A_re, A_A_im, A_B_re, A_B_im, A_C_re, A_C_im, A_log_dt, A_Dskip, B_x, B_w1, B_w2):
    def _A_ref(u, A_re, A_im, B_re, B_im, C_re, C_im, log_dt, Dskip):
        Bsz, L, D = u.shape
        dt = torch.exp(log_dt)[:, None]
        A = A_re + 1j * A_im
        Bc = B_re + 1j * B_im
        Cc = C_re + 1j * C_im
        logdA = dt * A
        dB = dt * Bc
        l = (lambda x, dt: x.to(dt))(torch.arange(L), A_re.dtype)
        P = torch.exp(logdA[:, :, None] * l[None, None, :])
        K = torch.einsum("dn,dnl,dn->dl", Cc, P, dB).real
        L2 = 2 * L
        Kp = _pad(K, ((0, 0), (0, L)))
        up = (lambda x, *d: x.permute(*d))(u, 0, 2, 1)
        up = _pad(up, ((0, 0), (0, 0), (0, L)))
        Kf = (lambda x, axes=(-2,-1): torch.fft.rfft2(x.float(), dim=axes))(Kp[:, None, :], axes=(-2, -1))
        Uf = (lambda x, axes=(-2,-1): torch.fft.rfft2(x.float(), dim=axes))(up[:, :, None, :], axes=(-2, -1))
        Yf = Uf * Kf[None, :, :, :]
        y = (lambda x, s, axes=(-2,-1): torch.fft.irfft2(x, s=s, dim=axes).to(torch.bfloat16))(Yf, (1, L2), axes=(-2, -1))[:, :, 0, :L]
        y = (lambda x, *d: x.permute(*d))(y, 0, 2, 1) + u * Dskip[None, None, :]
        return y

    def _B_ref(x, w1, w2):
        h = torch.einsum("bsd,df->bsf", x, w1)
        zero = torch.zeros_like(h)
        h = torch.maximum(h, zero)
        return torch.einsum("bsf,fd->bsd", h, w2)

    x = A_u
    xn = _layernorm(x, axis=-1)
    return x + _A_ref(xn, A_A_re, A_A_im, A_B_re, A_B_im, A_C_re, A_C_im, A_log_dt, A_Dskip) + _B_ref(xn, B_w1, B_w2)
```

```asm
; @launch grid=(480,1,1) block=(512,1,1) lds=81920
.amdgcn_target "amdgcn-amd-amdhsa--gfx950"
.text
.globl parallel_sum__ssm_conv_s4__dense_activation_relu__prompt_kernel
.p2align 8
.type parallel_sum__ssm_conv_s4__dense_activation_relu__prompt_kernel,@function
parallel_sum__ssm_conv_s4__dense_activation_relu__prompt_kernel:
  s_load_dwordx16 s[16:31], s[0:1], 0
  s_load_dwordx8 s[32:39], s[0:1], 64
  s_load_dwordx4 s[40:43], s[0:1], 96
  s_load_dwordx2 s[44:45], s[0:1], 112
  s_cmp_lt_u32 s2, 224
  s_cbranch_scc1 L_B
  s_cmp_lt_u32 s2, 256
  s_cbranch_scc1 L_LN
  s_cmp_ge_u32 s2, 480
  s_cbranch_scc1 L_end
  s_waitcnt lgkmcnt(0)
  s_add_u32 s80, s44, 0x1400000
  s_addc_u32 s81, s45, 0
  s_mov_b32 s82, 0x20000
  s_mov_b32 s83, 0x00020000
  s_load_dword s46, s[80:81], 0
  s_sub_u32 s3, s2, 256
  s_lshr_b32 s14, s3, 3
  s_mul_hi_u32 s5, s14, 0x24924925
  s_mul_i32 s13, s5, 7
  s_sub_u32 s13, s14, s13
  s_and_b32 s6, s3, 1
  s_mul_i32 s6, s6, 7
  s_add_u32 s13, s13, s6
  s_bfe_u32 s12, s3, 0x20001
  s_lshl_b32 s12, s12, 2
  s_add_u32 s12, s12, s5
  s_mul_i32 s92, s12, 14
  s_add_u32 s92, s92, s13
  s_lshl_b32 s92, s92, 7
  s_add_u32 s92, s92, 8192
  s_mov_b32 s91, 0
  v_lshrrev_b32 v2, 6, v0
  v_and_b32 v3, 63, v0
  v_readfirstlane_b32 s7, v2
  s_nop 0
  s_cmp_lt_u32 s7, 4
  s_cbranch_scc1 L_g1_compute
  s_mov_b32 s48, s16
  s_mov_b32 s49, s17
  s_mov_b32 s50, 0x1c0000
  s_mov_b32 s51, 0x00020000
  s_mov_b32 s52, s36
  s_mov_b32 s53, s37
  s_mov_b32 s54, 0x188000
  s_mov_b32 s55, 0x00020000
  s_sub_u32 s15, s7, 4
  v_lshrrev_b32 v8, 2, v3
  v_and_b32 v4, 3, v3
  v_bfe_u32 v5, v3, 4, 2
  v_xor_b32 v4, v4, v5
  v_mul_u32_u24 v8, 896, v8
  v_lshl_add_u32 v8, v4, 4, v8
  v_lshrrev_b32 v9, 4, v3
  v_and_b32 v5, 15, v3
  v_lshlrev_b32 v6, 2, v9
  v_xor_b32 v5, v5, v6
  v_mul_u32_u24 v9, 3584, v9
  v_lshl_add_u32 v9, v5, 4, v9
  s_lshl_b32 s8, s12, 2
  s_add_u32 s8, s8, s15
  s_mul_i32 s8, s8, 28672
  s_mul_i32 s9, s15, 28672
  s_lshl_b32 s5, s13, 8
  s_add_u32 s9, s9, s5
  s_lshl_b32 s10, s15, 11
  s_add_u32 m0, s10, 0
  s_add_u32 s5, s8, 14336
  buffer_load_dwordx4 v8, s[48:51], s8 offen lds
  s_add_u32 m0, s10, 40960
  s_add_u32 s6, s9, 14336
  buffer_load_dwordx4 v9, s[52:55], s9 offen lds
  s_add_u32 m0, s10, 1024
  s_add_u32 s8, s8, 64
  buffer_load_dwordx4 v8, s[48:51], s5 offen lds
  s_add_u32 m0, s10, 41984
  s_add_u32 s9, s9, 114688
  buffer_load_dwordx4 v9, s[52:55], s6 offen lds
  s_add_u32 m0, s10, 8192
  s_add_u32 s5, s8, 14336
  buffer_load_dwordx4 v8, s[48:51], s8 offen lds
  s_add_u32 m0, s10, 49152
  s_add_u32 s6, s9, 14336
  buffer_load_dwordx4 v9, s[52:55], s9 offen lds
  s_add_u32 m0, s10, 9216
  s_add_u32 s8, s8, 64
  buffer_load_dwordx4 v8, s[48:51], s5 offen lds
  s_add_u32 m0, s10, 50176
  s_add_u32 s9, s9, 114688
  buffer_load_dwordx4 v9, s[52:55], s6 offen lds
  s_add_u32 m0, s10, 16384
  s_add_u32 s5, s8, 14336
  buffer_load_dwordx4 v8, s[48:51], s8 offen lds
  s_add_u32 m0, s10, 57344
  s_add_u32 s6, s9, 14336
  buffer_load_dwordx4 v9, s[52:55], s9 offen lds
  s_add_u32 m0, s10, 17408
  s_add_u32 s8, s8, 64
  buffer_load_dwordx4 v8, s[48:51], s5 offen lds
  s_add_u32 m0, s10, 58368
  s_add_u32 s9, s9, 114688
  buffer_load_dwordx4 v9, s[52:55], s6 offen lds
  s_add_u32 m0, s10, 24576
  s_add_u32 s5, s8, 14336
  buffer_load_dwordx4 v8, s[48:51], s8 offen lds
  s_add_u32 m0, s10, 65536
  s_add_u32 s6, s9, 14336
  buffer_load_dwordx4 v9, s[52:55], s9 offen lds
  s_add_u32 m0, s10, 25600
  s_add_u32 s8, s8, 64
  buffer_load_dwordx4 v8, s[48:51], s5 offen lds
  s_add_u32 m0, s10, 66560
  s_add_u32 s9, s9, 114688
  buffer_load_dwordx4 v9, s[52:55], s6 offen lds
  s_add_u32 s60, s44, 0x1300000
  s_addc_u32 s61, s45, 0
  s_mov_b32 s62, 0x4000
  s_mov_b32 s63, 0x00020000
  s_cmp_eq_u32 s15, 0
  s_cselect_b32 s5, 0, 0x7ffffff0
  v_and_b32 v13, 1, v3
  v_lshlrev_b32 v13, 7, v13
  v_add_u32 v13, s5, v13
  v_mov_b32 v15, s5
  s_lshl_b32 s72, s12, 8
  s_add_u32 s72, s72, 4096
  s_waitcnt lgkmcnt(0)
  s_add_u32 s46, s46, 1
  s_waitcnt vmcnt(12)
  s_barrier
  v_add_u32 v10, -256, v0
  s_mul_i32 s5, s14, 224
  v_add_u32 v5, s5, v10
  s_mov_b32 s6, 0x12492493
  v_mul_hi_u32 v6, v5, s6
  v_mul_u32_u24 v7, 14, v6
  v_sub_u32 v7, v5, v7
  v_mul_u32_u24 v6, 3584, v6
  v_lshl_add_u32 v6, v7, 7, v6
  s_and_b32 s6, s3, 1
  s_mul_i32 s6, s6, 1792
  v_cmp_gt_u32 vcc, 224, v10
  v_mov_b32 v7, 0x7ffffff0
  s_nop 0
  v_cndmask_b32 v6, v7, v6, vcc
  buffer_load_dword v11, v6, s[52:55], s6 offen
  s_bfe_u32 s5, s3, 0x20001
  s_mul_i32 s5, s5, 458752
  s_lshl_b32 s6, s14, 14
  s_add_u32 s5, s5, s6
  v_lshlrev_b32 v5, 7, v10
  v_cmp_gt_u32 vcc, 128, v10
  v_mov_b32 v7, 0x7ffffff0
  s_nop 0
  v_cndmask_b32 v6, v7, v5, vcc
  buffer_load_dword v12, v6, s[48:51], s5 offen
  s_waitcnt vmcnt(10)
  s_barrier
  s_add_u32 m0, s10, 32768
  s_add_u32 s5, s8, 14336
  buffer_load_dwordx4 v8, s[48:51], s8 offen lds
  s_add_u32 m0, s10, 73728
  s_add_u32 s6, s9, 14336
  buffer_load_dwordx4 v9, s[52:55], s9 offen lds
  s_add_u32 m0, s10, 33792
  s_add_u32 s8, s8, 64
  buffer_load_dwordx4 v8, s[48:51], s5 offen lds
  s_add_u32 m0, s10, 74752
  s_add_u32 s9, s9, 114688
  buffer_load_dwordx4 v9, s[52:55], s6 offen lds
  s_waitcnt vmcnt(10)
  s_barrier
  s_add_u32 m0, s10, 0
  s_add_u32 s5, s8, 14336
  buffer_load_dwordx4 v8, s[48:51], s8 offen lds
  s_add_u32 m0, s10, 40960
  s_add_u32 s6, s9, 14336
  buffer_load_dwordx4 v9, s[52:55], s9 offen lds
  s_add_u32 m0, s10, 1024
  s_add_u32 s8, s8, 64
  buffer_load_dwordx4 v8, s[48:51], s5 offen lds
  s_add_u32 m0, s10, 41984
  s_add_u32 s9, s9, 114688
  buffer_load_dwordx4 v9, s[52:55], s6 offen lds
  s_waitcnt vmcnt(10)
  s_barrier
  s_add_u32 m0, s10, 8192
  s_add_u32 s5, s8, 14336
  buffer_load_dwordx4 v8, s[48:51], s8 offen lds
  s_add_u32 m0, s10, 49152
  s_add_u32 s6, s9, 14336
  buffer_load_dwordx4 v9, s[52:55], s9 offen lds
  s_add_u32 m0, s10, 9216
  s_add_u32 s8, s8, 64
  buffer_load_dwordx4 v8, s[48:51], s5 offen lds
  s_add_u32 m0, s10, 50176
  s_add_u32 s9, s9, 114688
  buffer_load_dwordx4 v9, s[52:55], s6 offen lds
  s_waitcnt vmcnt(8)
  s_barrier
  s_add_u32 m0, s10, 16384
  s_add_u32 s5, s8, 14336
  buffer_load_dwordx4 v8, s[48:51], s8 offen lds
  s_add_u32 m0, s10, 57344
  s_add_u32 s6, s9, 14336
  buffer_load_dwordx4 v9, s[52:55], s9 offen lds
  s_add_u32 m0, s10, 17408
  s_add_u32 s8, s8, 64
  buffer_load_dwordx4 v8, s[48:51], s5 offen lds
  s_add_u32 m0, s10, 58368
  s_add_u32 s9, s9, 114688
  buffer_load_dwordx4 v9, s[52:55], s6 offen lds
  s_waitcnt vmcnt(8)
  s_barrier
  s_add_u32 m0, s10, 24576
  s_add_u32 s5, s8, 14336
  buffer_load_dwordx4 v8, s[48:51], s8 offen lds
  s_add_u32 m0, s10, 65536
  s_add_u32 s6, s9, 14336
  buffer_load_dwordx4 v9, s[52:55], s9 offen lds
  s_add_u32 m0, s10, 25600
  s_add_u32 s8, s8, 64
  buffer_load_dwordx4 v8, s[48:51], s5 offen lds
  s_add_u32 m0, s10, 66560
  s_add_u32 s9, s9, 114688
  buffer_load_dwordx4 v9, s[52:55], s6 offen lds
  s_waitcnt vmcnt(8)
  s_barrier
  s_add_u32 m0, s10, 32768
  s_add_u32 s5, s8, 14336
  buffer_load_dwordx4 v8, s[48:51], s8 offen lds
  s_add_u32 m0, s10, 73728
  s_add_u32 s6, s9, 14336
  buffer_load_dwordx4 v9, s[52:55], s9 offen lds
  s_add_u32 m0, s10, 33792
  s_add_u32 s8, s8, 64
  buffer_load_dwordx4 v8, s[48:51], s5 offen lds
  s_add_u32 m0, s10, 74752
  s_add_u32 s9, s9, 114688
  buffer_load_dwordx4 v9, s[52:55], s6 offen lds
  s_waitcnt vmcnt(8)
  s_barrier
  s_add_u32 m0, s10, 0
  s_add_u32 s5, s8, 14336
  buffer_load_dwordx4 v8, s[48:51], s8 offen lds
  s_add_u32 m0, s10, 40960
  s_add_u32 s6, s9, 14336
  buffer_load_dwordx4 v9, s[52:55], s9 offen lds
  s_add_u32 m0, s10, 1024
  s_add_u32 s8, s8, 64
  buffer_load_dwordx4 v8, s[48:51], s5 offen lds
  s_add_u32 m0, s10, 41984
  s_add_u32 s9, s9, 114688
  buffer_load_dwordx4 v9, s[52:55], s6 offen lds
  s_waitcnt vmcnt(8)
  s_barrier
  s_add_u32 m0, s10, 8192
  s_add_u32 s5, s8, 14336
  buffer_load_dwordx4 v8, s[48:51], s8 offen lds
  s_add_u32 m0, s10, 49152
  s_add_u32 s6, s9, 14336
  buffer_load_dwordx4 v9, s[52:55], s9 offen lds
  s_add_u32 m0, s10, 9216
  s_add_u32 s8, s8, 64
  buffer_load_dwordx4 v8, s[48:51], s5 offen lds
  s_add_u32 m0, s10, 50176
  s_add_u32 s9, s9, 114688
  buffer_load_dwordx4 v9, s[52:55], s6 offen lds
  s_waitcnt vmcnt(8)
  s_barrier
  s_add_u32 m0, s10, 16384
  s_add_u32 s5, s8, 14336
  buffer_load_dwordx4 v8, s[48:51], s8 offen lds
  s_add_u32 m0, s10, 57344
  s_add_u32 s6, s9, 14336
  buffer_load_dwordx4 v9, s[52:55], s9 offen lds
  s_add_u32 m0, s10, 17408
  s_add_u32 s8, s8, 64
  buffer_load_dwordx4 v8, s[48:51], s5 offen lds
  s_add_u32 m0, s10, 58368
  s_add_u32 s9, s9, 114688
  buffer_load_dwordx4 v9, s[52:55], s6 offen lds
  buffer_load_dword v14, v13, s[80:83], s72 offen sc1
  s_waitcnt vmcnt(9)
  s_barrier
  s_add_u32 m0, s10, 24576
  s_add_u32 s5, s8, 14336
  buffer_load_dwordx4 v8, s[48:51], s8 offen lds
  s_add_u32 m0, s10, 65536
  s_add_u32 s6, s9, 14336
  buffer_load_dwordx4 v9, s[52:55], s9 offen lds
  s_add_u32 m0, s10, 25600
  s_add_u32 s8, s8, 64
  buffer_load_dwordx4 v8, s[48:51], s5 offen lds
  s_add_u32 m0, s10, 66560
  s_add_u32 s9, s9, 114688
  buffer_load_dwordx4 v9, s[52:55], s6 offen lds
  s_waitcnt vmcnt(9)
  s_barrier
  s_waitcnt vmcnt(5)
  s_barrier
  s_waitcnt vmcnt(4)
  s_cmp_eq_u32 s15, 0
  s_cbranch_scc0 L_g1sk_1
  s_mov_b32 s77, 0
L_g1sp_2:
  v_cmp_ne_u32 vcc, s46, v14
  s_nop 4
  s_cbranch_vccz L_g1sk_1
  s_add_u32 s77, s77, 1
  s_cmp_ge_u32 s77, 0x80000
  s_cbranch_scc1 L_g1sk_1
  s_sleep 8
  buffer_load_dword v14, v13, s[80:83], s72 offen sc1
  s_waitcnt vmcnt(0)
  s_branch L_g1sp_2
L_g1sk_1:
  s_lshl_b32 s5, s12, 10
  v_lshlrev_b32 v14, 4, v3
  v_add_u32 v14, v15, v14
  buffer_load_dwordx4 v[16:19], v14, s[60:63], s5 offen sc1
  s_waitcnt vmcnt(1)
  s_barrier
  s_cmp_eq_u32 s15, 0
  s_cbranch_scc0 L_g1ldend_3
  s_waitcnt vmcnt(0)
  ds_write_b128 v14, v[16:19] offset:33792
  s_waitcnt lgkmcnt(0)
L_g1ldend_3:
  s_waitcnt vmcnt(0)
  s_barrier
  s_add_u32 s48, s44, 0x700000
  s_addc_u32 s49, s45, 0
  s_mov_b32 s50, 0x188000
  s_mov_b32 s51, 0x00020000
  s_mov_b32 s52, s44
  s_mov_b32 s53, s45
  s_mov_b32 s54, 0x700000
  s_mov_b32 s55, 0x00020000
  s_lshr_b32 s14, s3, 3
  s_mul_hi_u32 s5, s14, 0x24924925
  s_mul_i32 s13, s5, 7
  s_sub_u32 s13, s14, s13
  s_and_b32 s12, s3, 7
  s_lshl_b32 s12, s12, 2
  s_add_u32 s12, s12, s5
  v_and_b32 v2, 63, v0
  v_lshlrev_b32 v3, 4, v2
  s_mul_i32 s4, s7, 14
  s_lshl_b32 s5, s13, 1
  s_mul_i32 s5, s5, 112
  s_add_u32 s5, s5, s4
  s_lshl_b32 s68, s5, 10
  s_add_u32 s69, s68, 114688
  s_lshl_b32 s5, s12, 1
  s_mul_i32 s5, s5, 112
  s_add_u32 s5, s5, s4
  s_lshl_b32 s70, s5, 10
  s_add_u32 s71, s70, 114688
  v_mov_b32 v64, 0
  v_mov_b32 v65, 0
  v_mov_b32 v66, 0
  v_mov_b32 v67, 0
  v_mov_b32 v68, 0
  v_mov_b32 v69, 0
  v_mov_b32 v70, 0
  v_mov_b32 v71, 0
  v_mov_b32 v72, 0
  v_mov_b32 v73, 0
  v_mov_b32 v74, 0
  v_mov_b32 v75, 0
  v_mov_b32 v76, 0
  v_mov_b32 v77, 0
  v_mov_b32 v78, 0
  v_mov_b32 v79, 0
  v_mov_b32 v80, 0
  v_mov_b32 v81, 0
  v_mov_b32 v82, 0
  v_mov_b32 v83, 0
  v_mov_b32 v84, 0
  v_mov_b32 v85, 0
  v_mov_b32 v86, 0
  v_mov_b32 v87, 0
  v_mov_b32 v88, 0
  v_mov_b32 v89, 0
  v_mov_b32 v90, 0
  v_mov_b32 v91, 0
  v_mov_b32 v92, 0
  v_mov_b32 v93, 0
  v_mov_b32 v94, 0
  v_mov_b32 v95, 0
  v_mov_b32 v96, 0
  v_mov_b32 v97, 0
  v_mov_b32 v98, 0
  v_mov_b32 v99, 0
  v_mov_b32 v100, 0
  v_mov_b32 v101, 0
  v_mov_b32 v102, 0
  v_mov_b32 v103, 0
  v_mov_b32 v104, 0
  v_mov_b32 v105, 0
  v_mov_b32 v106, 0
  v_mov_b32 v107, 0
  v_mov_b32 v108, 0
  v_mov_b32 v109, 0
  v_mov_b32 v110, 0
  v_mov_b32 v111, 0
  v_mov_b32 v112, 0
  v_mov_b32 v113, 0
  v_mov_b32 v114, 0
  v_mov_b32 v115, 0
  v_mov_b32 v116, 0
  v_mov_b32 v117, 0
  v_mov_b32 v118, 0
  v_mov_b32 v119, 0
  v_mov_b32 v120, 0
  v_mov_b32 v121, 0
  v_mov_b32 v122, 0
  v_mov_b32 v123, 0
  v_mov_b32 v124, 0
  v_mov_b32 v125, 0
  v_mov_b32 v126, 0
  v_mov_b32 v127, 0
  s_mul_i32 s90, s7, 10240
  s_mov_b32 s91, 1
  v_lshlrev_b32 v4, 4, v2
  s_mov_b32 s9, 36864
  s_mov_b32 exec_hi, 0xffffff
  buffer_load_dwordx4 v[8:11], v4, s[80:83], s9 offen sc1
  s_waitcnt vmcnt(0)
  v_cmp_ne_u32 vcc, s46, v8
  v_cmp_ne_u32 s[88:89], s46, v9
  s_nop 0
  s_or_b64 vcc, vcc, s[88:89]
  v_cmp_ne_u32 s[88:89], s46, v10
  s_nop 0
  s_or_b64 vcc, vcc, s[88:89]
  v_cmp_ne_u32 s[88:89], s46, v11
  s_nop 0
  s_or_b64 vcc, vcc, s[88:89]
  s_mov_b64 exec, -1
  s_cbranch_vccnz L_g2early_4
  s_add_u32 m0, s90, 0
  s_nop 0
  buffer_load_dwordx4 v3, s[48:51], s68 offen sc1 lds
  s_add_u32 s68, s68, 1024
  s_add_u32 m0, s90, 1024
  s_nop 0
  buffer_load_dwordx4 v3, s[48:51], s69 offen sc1 lds
  s_add_u32 s69, s69, 1024
  s_add_u32 m0, s90, 2048
  s_nop 0
  buffer_load_dwordx4 v3, s[48:51], s68 offen sc1 lds
  s_add_u32 s68, s68, 1024
  s_add_u32 m0, s90, 3072
  s_nop 0
  buffer_load_dwordx4 v3, s[48:51], s69 offen sc1 lds
  s_add_u32 s69, s69, 1024
  s_add_u32 m0, s90, 4096
  s_nop 0
  buffer_load_dwordx4 v3, s[48:51], s68 offen sc1 lds
  s_add_u32 s68, s68, 1024
  s_add_u32 m0, s90, 5120
  s_nop 0
  buffer_load_dwordx4 v3, s[48:51], s69 offen sc1 lds
  s_add_u32 s69, s69, 1024
  s_add_u32 m0, s90, 6144
  s_nop 0
  buffer_load_dwordx4 v3, s[48:51], s68 offen sc1 lds
  s_add_u32 s68, s68, 1024
  s_add_u32 m0, s90, 7168
  s_nop 0
  buffer_load_dwordx4 v3, s[48:51], s69 offen sc1 lds
  s_add_u32 s69, s69, 1024
  s_add_u32 m0, s90, 8192
  s_nop 0
  buffer_load_dwordx4 v3, s[48:51], s68 offen sc1 lds
  s_add_u32 s68, s68, 1024
  s_add_u32 m0, s90, 9216
  s_nop 0
  buffer_load_dwordx4 v3, s[48:51], s69 offen sc1 lds
  s_add_u32 s69, s69, 1024
  s_waitcnt vmcnt(0)
  s_mov_b32 s91, 2
L_g2early_4:
  s_branch L_g1_done
L_g1_compute:
  s_setprio 1
  s_mov_b32 s56, s44
  s_mov_b32 s57, s45
  s_mov_b32 s58, 0x700000
  s_mov_b32 s59, 0x00020000
  s_and_b32 s15, s7, 1
  s_lshr_b32 s11, s7, 1
  v_and_b32 v4, 31, v3
  v_lshrrev_b32 v6, 5, v3
  v_bfe_u32 v7, v3, 2, 2
  v_xor_b32 v7, v7, v6
  v_lshlrev_b32 v4, 6, v4
  v_lshl_add_u32 v4, v7, 4, v4
  s_lshl_b32 s5, s11, 12
  v_add_u32 v4, s5, v4
  v_xor_b32 v5, 32, v4
  v_bfe_u32 v7, v3, 2, 2
  v_lshl_add_u32 v8, v6, 3, v7
  v_lshlrev_b32 v8, 8, v8
  v_bfe_u32 v9, v3, 4, 1
  v_lshl_add_u32 v8, v9, 5, v8
  v_and_b32 v9, 3, v3
  v_lshl_add_u32 v8, v9, 3, v8
  v_add_u32 v8, 40960, v8
  s_lshl_b32 s5, s15, 1
  s_add_u32 s68, s5, s11
  s_xor_b32 s69, s68, 1
  v_xor_b32 v9, s69, v7
  v_xor_b32 v6, s68, v7
  v_lshl_add_u32 v7, v9, 6, v8
  v_lshl_add_u32 v6, v6, 6, v8
  v_and_b32 v2, 31, v3
  v_cmp_eq_u32 vcc, 0, v2
  v_cmp_eq_u32 s[70:71], 17, v2
  s_nop 0
  s_or_b64 vcc, vcc, s[70:71]
  v_mov_b32 v2, 0x3f803f80
  v_cndmask_b32 v8, 0, v2, vcc
  v_mov_b32 v9, v8
  v_mov_b32 v10, v8
  v_mov_b32 v11, v8
  v_mov_b32 v12, 0
  v_mov_b32 v13, 0
  v_mov_b32 v14, 0
  v_mov_b32 v15, 0
  v_mov_b32 v64, 0
  v_mov_b32 v65, 0
  v_mov_b32 v66, 0
  v_mov_b32 v67, 0
  v_mov_b32 v68, 0
  v_mov_b32 v69, 0
  v_mov_b32 v70, 0
  v_mov_b32 v71, 0
  v_mov_b32 v72, 0
  v_mov_b32 v73, 0
  v_mov_b32 v74, 0
  v_mov_b32 v75, 0
  v_mov_b32 v76, 0
  v_mov_b32 v77, 0
  v_mov_b32 v78, 0
  v_mov_b32 v79, 0
  v_mov_b32 v80, 0
  v_mov_b32 v81, 0
  v_mov_b32 v82, 0
  v_mov_b32 v83, 0
  v_mov_b32 v84, 0
  v_mov_b32 v85, 0
  v_mov_b32 v86, 0
  v_mov_b32 v87, 0
  v_mov_b32 v88, 0
  v_mov_b32 v89, 0
  v_mov_b32 v90, 0
  v_mov_b32 v91, 0
  v_mov_b32 v92, 0
  v_mov_b32 v93, 0
  v_mov_b32 v94, 0
  v_mov_b32 v95, 0
  v_mov_b32 v96, 0
  v_mov_b32 v97, 0
  v_mov_b32 v98, 0
  v_mov_b32 v99, 0
  v_mov_b32 v100, 0
  v_mov_b32 v101, 0
  v_mov_b32 v102, 0
  v_mov_b32 v103, 0
  v_mov_b32 v104, 0
  v_mov_b32 v105, 0
  v_mov_b32 v106, 0
  v_mov_b32 v107, 0
  v_mov_b32 v108, 0
  v_mov_b32 v109, 0
  v_mov_b32 v110, 0
  v_mov_b32 v111, 0
  v_mov_b32 v112, 0
  v_mov_b32 v113, 0
  v_mov_b32 v114, 0
  v_mov_b32 v115, 0
  v_mov_b32 v116, 0
  v_mov_b32 v117, 0
  v_mov_b32 v118, 0
  v_mov_b32 v119, 0
  v_mov_b32 v120, 0
  v_mov_b32 v121, 0
  v_mov_b32 v122, 0
  v_mov_b32 v123, 0
  v_mov_b32 v124, 0
  v_mov_b32 v125, 0
  v_mov_b32 v126, 0
  v_mov_b32 v127, 0
  s_waitcnt lgkmcnt(0)
  s_add_u32 s46, s46, 1
  s_barrier
  ds_read_b64_tr_b16 v[16:17], v6 offset:0
  ds_read_b64_tr_b16 v[18:19], v6 offset:1024
  ds_read_b128 v[24:27], v4 offset:0
  ds_read_b128 v[28:31], v4 offset:2048
  ds_read_b64_tr_b16 v[20:21], v7 offset:0
  ds_read_b64_tr_b16 v[22:23], v7 offset:1024
  ds_read_b64_tr_b16 v[32:33], v6 offset:4096
  ds_read_b64_tr_b16 v[34:35], v6 offset:5120
  ds_read_b128 v[40:43], v5 offset:0
  ds_read_b128 v[44:47], v5 offset:2048
  ds_read_b64_tr_b16 v[36:37], v7 offset:4096
  ds_read_b64_tr_b16 v[38:39], v7 offset:5120
  s_barrier
  s_waitcnt lgkmcnt(6)
  v_mfma_f32_32x32x16_bf16 v[64:79], v[16:19], v[24:27], v[64:79]
  ds_read_b64_tr_b16 v[48:49], v6 offset:8192
  v_mfma_f32_32x32x16_bf16 v[80:95], v[16:19], v[28:31], v[80:95]
  ds_read_b64_tr_b16 v[50:51], v6 offset:9216
  ds_read_b128 v[56:59], v4 offset:8192
  v_mfma_f32_32x32x16_bf16 v[96:111], v[20:23], v[24:27], v[96:111]
  ds_read_b128 v[60:63], v4 offset:10240
  v_mfma_f32_32x32x16_bf16 v[112:127], v[20:23], v[28:31], v[112:127]
  ds_read_b64_tr_b16 v[52:53], v7 offset:8192
  ds_read_b64_tr_b16 v[54:55], v7 offset:9216
  v_mfma_f32_16x16x32_bf16 v[12:15], v[8:11], v[16:19], v[12:15]
  s_waitcnt lgkmcnt(6)
  v_mfma_f32_32x32x16_bf16 v[64:79], v[32:35], v[40:43], v[64:79]
  ds_read_b64_tr_b16 v[16:17], v6 offset:12288
  v_mfma_f32_32x32x16_bf16 v[80:95], v[32:35], v[44:47], v[80:95]
  ds_read_b64_tr_b16 v[18:19], v6 offset:13312
  ds_read_b128 v[24:27], v5 offset:8192
  v_mfma_f32_32x32x16_bf16 v[96:111], v[36:39], v[40:43], v[96:111]
  ds_read_b128 v[28:31], v5 offset:10240
  v_mfma_f32_32x32x16_bf16 v[112:127], v[36:39], v[44:47], v[112:127]
  ds_read_b64_tr_b16 v[20:21], v7 offset:12288
  ds_read_b64_tr_b16 v[22:23], v7 offset:13312
  v_mfma_f32_16x16x32_bf16 v[12:15], v[8:11], v[32:35], v[12:15]
  s_barrier
  s_waitcnt lgkmcnt(6)
  v_mfma_f32_32x32x16_bf16 v[64:79], v[48:51], v[56:59], v[64:79]
  ds_read_b64_tr_b16 v[32:33], v6 offset:16384
  v_mfma_f32_32x32x16_bf16 v[80:95], v[48:51], v[60:63], v[80:95]
  ds_read_b64_tr_b16 v[34:35], v6 offset:17408
  ds_read_b128 v[40:43], v4 offset:16384
  v_mfma_f32_32x32x16_bf16 v[96:111], v[52:55], v[56:59], v[96:111]
  ds_read_b128 v[44:47], v4 offset:18432
  v_mfma_f32_32x32x16_bf16 v[112:127], v[52:55], v[60:63], v[112:127]
  ds_read_b64_tr_b16 v[36:37], v7 offset:16384
  ds_read_b64_tr_b16 v[38:39], v7 offset:17408
  v_mfma_f32_16x16x32_bf16 v[12:15], v[8:11], v[48:51], v[12:15]
  s_waitcnt lgkmcnt(6)
  v_mfma_f32_32x32x16_bf16 v[64:79], v[16:19], v[24:27], v[64:79]
  ds_read_b64_tr_b16 v[48:49], v6 offset:20480
  v_mfma_f32_32x32x16_bf16 v[80:95], v[16:19], v[28:31], v[80:95]
  ds_read_b64_tr_b16 v[50:51], v6 offset:21504
  ds_read_b128 v[56:59], v5 offset:16384
  v_mfma_f32_32x32x16_bf16 v[96:111], v[20:23], v[24:27], v[96:111]
  ds_read_b128 v[60:63], v5 offset:18432
  v_mfma_f32_32x32x16_bf16 v[112:127], v[20:23], v[28:31], v[112:127]
  ds_read_b64_tr_b16 v[52:53], v7 offset:20480
  ds_read_b64_tr_b16 v[54:55], v7 offset:21504
  v_mfma_f32_16x16x32_bf16 v[12:15], v[8:11], v[16:19], v[12:15]
  s_barrier
  s_waitcnt lgkmcnt(6)
  v_mfma_f32_32x32x16_bf16 v[64:79], v[32:35], v[40:43], v[64:79]
  ds_read_b64_tr_b16 v[16:17], v6 offset:24576
  v_mfma_f32_32x32x16_bf16 v[80:95], v[32:35], v[44:47], v[80:95]
  ds_read_b64_tr_b16 v[18:19], v6 offset:25600
  ds_read_b128 v[24:27], v4 offset:24576
  v_mfma_f32_32x32x16_bf16 v[96:111], v[36:39], v[40:43], v[96:111]
  ds_read_b128 v[28:31], v4 offset:26624
  v_mfma_f32_32x32x16_bf16 v[112:127], v[36:39], v[44:47], v[112:127]
  ds_read_b64_tr_b16 v[20:21], v7 offset:24576
  ds_read_b64_tr_b16 v[22:23], v7 offset:25600
  v_mfma_f32_16x16x32_bf16 v[12:15], v[8:11], v[32:35], v[12:15]
  s_waitcnt lgkmcnt(6)
  v_mfma_f32_32x32x16_bf16 v[64:79], v[48:51], v[56:59], v[64:79]
  ds_read_b64_tr_b16 v[32:33], v6 offset:28672
  v_mfma_f32_32x32x16_bf16 v[80:95], v[48:51], v[60:63], v[80:95]
  ds_read_b64_tr_b16 v[34:35], v6 offset:29696
  ds_read_b128 v[40:43], v5 offset:24576
  v_mfma_f32_32x32x16_bf16 v[96:111], v[52:55], v[56:59], v[96:111]
  ds_read_b128 v[44:47], v5 offset:26624
  v_mfma_f32_32x32x16_bf16 v[112:127], v[52:55], v[60:63], v[112:127]
  ds_read_b64_tr_b16 v[36:37], v7 offset:28672
  ds_read_b64_tr_b16 v[38:39], v7 offset:29696
  v_mfma_f32_16x16x32_bf16 v[12:15], v[8:11], v[48:51], v[12:15]
  s_barrier
  s_waitcnt lgkmcnt(6)
  v_mfma_f32_32x32x16_bf16 v[64:79], v[16:19], v[24:27], v[64:79]
  ds_read_b64_tr_b16 v[48:49], v6 offset:32768
  v_mfma_f32_32x32x16_bf16 v[80:95], v[16:19], v[28:31], v[80:95]
  ds_read_b64_tr_b16 v[50:51], v6 offset:33792
  ds_read_b128 v[56:59], v4 offset:32768
  v_mfma_f32_32x32x16_bf16 v[96:111], v[20:23], v[24:27], v[96:111]
  ds_read_b128 v[60:63], v4 offset:34816
  v_mfma_f32_32x32x16_bf16 v[112:127], v[20:23], v[28:31], v[112:127]
  ds_read_b64_tr_b16 v[52:53], v7 offset:32768
  ds_read_b64_tr_b16 v[54:55], v7 offset:33792
  v_mfma_f32_16x16x32_bf16 v[12:15], v[8:11], v[16:19], v[12:15]
  s_waitcnt lgkmcnt(6)
  v_mfma_f32_32x32x16_bf16 v[64:79], v[32:35], v[40:43], v[64:79]
  ds_read_b64_tr_b16 v[16:17], v6 offset:36864
  v_mfma_f32_32x32x16_bf16 v[80:95], v[32:35], v[44:47], v[80:95]
  ds_read_b64_tr_b16 v[18:19], v6 offset:37888
  ds_read_b128 v[24:27], v5 offset:32768
  v_mfma_f32_32x32x16_bf16 v[96:111], v[36:39], v[40:43], v[96:111]
  ds_read_b128 v[28:31], v5 offset:34816
  v_mfma_f32_32x32x16_bf16 v[112:127], v[36:39], v[44:47], v[112:127]
  ds_read_b64_tr_b16 v[20:21], v7 offset:36864
  ds_read_b64_tr_b16 v[22:23], v7 offset:37888
  v_mfma_f32_16x16x32_bf16 v[12:15], v[8:11], v[32:35], v[12:15]
  s_barrier
  s_waitcnt lgkmcnt(6)
  v_mfma_f32_32x32x16_bf16 v[64:79], v[48:51], v[56:59], v[64:79]
  ds_read_b64_tr_b16 v[32:33], v6 offset:0
  v_mfma_f32_32x32x16_bf16 v[80:95], v[48:51], v[60:63], v[80:95]
  ds_read_b64_tr_b16 v[34:35], v6 offset:1024
  ds_read_b128 v[40:43], v4 offset:0
  v_mfma_f32_32x32x16_bf16 v[96:111], v[52:55], v[56:59], v[96:111]
  ds_read_b128 v[44:47], v4 offset:2048
  v_mfma_f32_32x32x16_bf16 v[112:127], v[52:55], v[60:63], v[112:127]
  ds_read_b64_tr_b16 v[36:37], v7 offset:0
  ds_read_b64_tr_b16 v[38:39], v7 offset:1024
  v_mfma_f32_16x16x32_bf16 v[12:15], v[8:11], v[48:51], v[12:15]
  s_waitcnt lgkmcnt(6)
  v_mfma_f32_32x32x16_bf16 v[64:79], v[16:19], v[24:27], v[64:79]
  ds_read_b64_tr_b16 v[48:49], v6 offset:4096
  v_mfma_f32_32x32x16_bf16 v[80:95], v[16:19], v[28:31], v[80:95]
  ds_read_b64_tr_b16 v[50:51], v6 offset:5120
  ds_read_b128 v[56:59], v5 offset:0
  v_mfma_f32_32x32x16_bf16 v[96:111], v[20:23], v[24:27], v[96:111]
  ds_read_b128 v[60:63], v5 offset:2048
  v_mfma_f32_32x32x16_bf16 v[112:127], v[20:23], v[28:31], v[112:127]
  ds_read_b64_tr_b16 v[52:53], v7 offset:4096
  ds_read_b64_tr_b16 v[54:55], v7 offset:5120
  v_mfma_f32_16x16x32_bf16 v[12:15], v[8:11], v[16:19], v[12:15]
  s_barrier
  s_waitcnt lgkmcnt(6)
  v_mfma_f32_32x32x16_bf16 v[64:79], v[32:35], v[40:43], v[64:79]
  ds_read_b64_tr_b16 v[16:17], v6 offset:8192
  v_mfma_f32_32x32x16_bf16 v[80:95], v[32:35], v[44:47], v[80:95]
  ds_read_b64_tr_b16 v[18:19], v6 offset:9216
  ds_read_b128 v[24:27], v4 offset:8192
  v_mfma_f32_32x32x16_bf16 v[96:111], v[36:39], v[40:43], v[96:111]
  ds_read_b128 v[28:31], v4 offset:10240
  v_mfma_f32_32x32x16_bf16 v[112:127], v[36:39], v[44:47], v[112:127]
  ds_read_b64_tr_b16 v[20:21], v7 offset:8192
  ds_read_b64_tr_b16 v[22:23], v7 offset:9216
  v_mfma_f32_16x16x32_bf16 v[12:15], v[8:11], v[32:35], v[12:15]
  s_waitcnt lgkmcnt(6)
  v_mfma_f32_32x32x16_bf16 v[64:79], v[48:51], v[56:59], v[64:79]
  ds_read_b64_tr_b16 v[32:33], v6 offset:12288
  v_mfma_f32_32x32x16_bf16 v[80:95], v[48:51], v[60:63], v[80:95]
  ds_read_b64_tr_b16 v[34:35], v6 offset:13312
  ds_read_b128 v[40:43], v5 offset:8192
  v_mfma_f32_32x32x16_bf16 v[96:111], v[52:55], v[56:59], v[96:111]
  ds_read_b128 v[44:47], v5 offset:10240
  v_mfma_f32_32x32x16_bf16 v[112:127], v[52:55], v[60:63], v[112:127]
  ds_read_b64_tr_b16 v[36:37], v7 offset:12288
  ds_read_b64_tr_b16 v[38:39], v7 offset:13312
  v_mfma_f32_16x16x32_bf16 v[12:15], v[8:11], v[48:51], v[12:15]
  s_barrier
  s_waitcnt lgkmcnt(6)
  v_mfma_f32_32x32x16_bf16 v[64:79], v[16:19], v[24:27], v[64:79]
  ds_read_b64_tr_b16 v[48:49], v6 offset:16384
  v_mfma_f32_32x32x16_bf16 v[80:95], v[16:19], v[28:31], v[80:95]
  ds_read_b64_tr_b16 v[50:51], v6 offset:17408
  ds_read_b128 v[56:59], v4 offset:16384
  v_mfma_f32_32x32x16_bf16 v[96:111], v[20:23], v[24:27], v[96:111]
  ds_read_b128 v[60:63], v4 offset:18432
  v_mfma_f32_32x32x16_bf16 v[112:127], v[20:23], v[28:31], v[112:127]
  ds_read_b64_tr_b16 v[52:53], v7 offset:16384
  ds_read_b64_tr_b16 v[54:55], v7 offset:17408
  v_mfma_f32_16x16x32_bf16 v[12:15], v[8:11], v[16:19], v[12:15]
  s_waitcnt lgkmcnt(6)
  v_mfma_f32_32x32x16_bf16 v[64:79], v[32:35], v[40:43], v[64:79]
  ds_read_b64_tr_b16 v[16:17], v6 offset:20480
  v_mfma_f32_32x32x16_bf16 v[80:95], v[32:35], v[44:47], v[80:95]
  ds_read_b64_tr_b16 v[18:19], v6 offset:21504
  ds_read_b128 v[24:27], v5 offset:16384
  v_mfma_f32_32x32x16_bf16 v[96:111], v[36:39], v[40:43], v[96:111]
  ds_read_b128 v[28:31], v5 offset:18432
  v_mfma_f32_32x32x16_bf16 v[112:127], v[36:39], v[44:47], v[112:127]
  ds_read_b64_tr_b16 v[20:21], v7 offset:20480
  ds_read_b64_tr_b16 v[22:23], v7 offset:21504
  v_mfma_f32_16x16x32_bf16 v[12:15], v[8:11], v[32:35], v[12:15]
  s_barrier
  s_waitcnt lgkmcnt(6)
  v_mfma_f32_32x32x16_bf16 v[64:79], v[48:51], v[56:59], v[64:79]
  ds_read_b64_tr_b16 v[32:33], v6 offset:24576
  v_mfma_f32_32x32x16_bf16 v[80:95], v[48:51], v[60:63], v[80:95]
  ds_read_b64_tr_b16 v[34:35], v6 offset:25600
  ds_read_b128 v[40:43], v4 offset:24576
  v_mfma_f32_32x32x16_bf16 v[96:111], v[52:55], v[56:59], v[96:111]
  ds_read_b128 v[44:47], v4 offset:26624
  v_mfma_f32_32x32x16_bf16 v[112:127], v[52:55], v[60:63], v[112:127]
  ds_read_b64_tr_b16 v[36:37], v7 offset:24576
  ds_read_b64_tr_b16 v[38:39], v7 offset:25600
  v_mfma_f32_16x16x32_bf16 v[12:15], v[8:11], v[48:51], v[12:15]
  s_waitcnt lgkmcnt(6)
  v_mfma_f32_32x32x16_bf16 v[64:79], v[16:19], v[24:27], v[64:79]
  ds_read_b64_tr_b16 v[48:49], v6 offset:28672
  v_mfma_f32_32x32x16_bf16 v[80:95], v[16:19], v[28:31], v[80:95]
  ds_read_b64_tr_b16 v[50:51], v6 offset:29696
  ds_read_b128 v[56:59], v5 offset:24576
  v_mfma_f32_32x32x16_bf16 v[96:111], v[20:23], v[24:27], v[96:111]
  ds_read_b128 v[60:63], v5 offset:26624
  v_mfma_f32_32x32x16_bf16 v[112:127], v[20:23], v[28:31], v[112:127]
  ds_read_b64_tr_b16 v[52:53], v7 offset:28672
  ds_read_b64_tr_b16 v[54:55], v7 offset:29696
  v_mfma_f32_16x16x32_bf16 v[12:15], v[8:11], v[16:19], v[12:15]
  s_barrier
  s_waitcnt lgkmcnt(6)
  v_mfma_f32_32x32x16_bf16 v[64:79], v[32:35], v[40:43], v[64:79]
  ds_read_b64_tr_b16 v[16:17], v6 offset:32768
  v_mfma_f32_32x32x16_bf16 v[80:95], v[32:35], v[44:47], v[80:95]
  ds_read_b64_tr_b16 v[18:19], v6 offset:33792
  ds_read_b128 v[24:27], v4 offset:32768
  v_mfma_f32_32x32x16_bf16 v[96:111], v[36:39], v[40:43], v[96:111]
  ds_read_b128 v[28:31], v4 offset:34816
  v_mfma_f32_32x32x16_bf16 v[112:127], v[36:39], v[44:47], v[112:127]
  ds_read_b64_tr_b16 v[20:21], v7 offset:32768
  ds_read_b64_tr_b16 v[22:23], v7 offset:33792
  v_mfma_f32_16x16x32_bf16 v[12:15], v[8:11], v[32:35], v[12:15]
  s_waitcnt lgkmcnt(6)
  v_mfma_f32_32x32x16_bf16 v[64:79], v[48:51], v[56:59], v[64:79]
  ds_read_b64_tr_b16 v[32:33], v6 offset:36864
  v_mfma_f32_32x32x16_bf16 v[80:95], v[48:51], v[60:63], v[80:95]
  ds_read_b64_tr_b16 v[34:35], v6 offset:37888
  ds_read_b128 v[40:43], v5 offset:32768
  v_mfma_f32_32x32x16_bf16 v[96:111], v[52:55], v[56:59], v[96:111]
  ds_read_b128 v[44:47], v5 offset:34816
  v_mfma_f32_32x32x16_bf16 v[112:127], v[52:55], v[60:63], v[112:127]
  ds_read_b64_tr_b16 v[36:37], v7 offset:36864
  ds_read_b64_tr_b16 v[38:39], v7 offset:37888
  v_mfma_f32_16x16x32_bf16 v[12:15], v[8:11], v[48:51], v[12:15]
  s_barrier
  s_waitcnt lgkmcnt(6)
  v_mfma_f32_32x32x16_bf16 v[64:79], v[16:19], v[24:27], v[64:79]
  ds_read_b64_tr_b16 v[48:49], v6 offset:0
  v_mfma_f32_32x32x16_bf16 v[80:95], v[16:19], v[28:31], v[80:95]
  ds_read_b64_tr_b16 v[50:51], v6 offset:1024
  ds_read_b128 v[56:59], v4 offset:0
  v_mfma_f32_32x32x16_bf16 v[96:111], v[20:23], v[24:27], v[96:111]
  ds_read_b128 v[60:63], v4 offset:2048
  v_mfma_f32_32x32x16_bf16 v[112:127], v[20:23], v[28:31], v[112:127]
  ds_read_b64_tr_b16 v[52:53], v7 offset:0
  ds_read_b64_tr_b16 v[54:55], v7 offset:1024
  v_mfma_f32_16x16x32_bf16 v[12:15], v[8:11], v[16:19], v[12:15]
  s_waitcnt lgkmcnt(6)
  v_mfma_f32_32x32x16_bf16 v[64:79], v[32:35], v[40:43], v[64:79]
  ds_read_b64_tr_b16 v[16:17], v6 offset:4096
  v_mfma_f32_32x32x16_bf16 v[80:95], v[32:35], v[44:47], v[80:95]
  ds_read_b64_tr_b16 v[18:19], v6 offset:5120
  ds_read_b128 v[24:27], v5 offset:0
  v_mfma_f32_32x32x16_bf16 v[96:111], v[36:39], v[40:43], v[96:111]
  ds_read_b128 v[28:31], v5 offset:2048
  v_mfma_f32_32x32x16_bf16 v[112:127], v[36:39], v[44:47], v[112:127]
  ds_read_b64_tr_b16 v[20:21], v7 offset:4096
  ds_read_b64_tr_b16 v[22:23], v7 offset:5120
  v_mfma_f32_16x16x32_bf16 v[12:15], v[8:11], v[32:35], v[12:15]
  s_barrier
  s_waitcnt lgkmcnt(6)
  v_mfma_f32_32x32x16_bf16 v[64:79], v[48:51], v[56:59], v[64:79]
  ds_read_b64_tr_b16 v[32:33], v6 offset:8192
  v_mfma_f32_32x32x16_bf16 v[80:95], v[48:51], v[60:63], v[80:95]
  ds_read_b64_tr_b16 v[34:35], v6 offset:9216
  ds_read_b128 v[40:43], v4 offset:8192
  v_mfma_f32_32x32x16_bf16 v[96:111], v[52:55], v[56:59], v[96:111]
  ds_read_b128 v[44:47], v4 offset:10240
  v_mfma_f32_32x32x16_bf16 v[112:127], v[52:55], v[60:63], v[112:127]
  ds_read_b64_tr_b16 v[36:37], v7 offset:8192
  ds_read_b64_tr_b16 v[38:39], v7 offset:9216
  v_mfma_f32_16x16x32_bf16 v[12:15], v[8:11], v[48:51], v[12:15]
  s_waitcnt lgkmcnt(6)
  v_mfma_f32_32x32x16_bf16 v[64:79], v[16:19], v[24:27], v[64:79]
  ds_read_b64_tr_b16 v[48:49], v6 offset:12288
  v_mfma_f32_32x32x16_bf16 v[80:95], v[16:19], v[28:31], v[80:95]
  ds_read_b64_tr_b16 v[50:51], v6 offset:13312
  ds_read_b128 v[56:59], v5 offset:8192
  v_mfma_f32_32x32x16_bf16 v[96:111], v[20:23], v[24:27], v[96:111]
  ds_read_b128 v[60:63], v5 offset:10240
  v_mfma_f32_32x32x16_bf16 v[112:127], v[20:23], v[28:31], v[112:127]
  ds_read_b64_tr_b16 v[52:53], v7 offset:12288
  ds_read_b64_tr_b16 v[54:55], v7 offset:13312
  v_mfma_f32_16x16x32_bf16 v[12:15], v[8:11], v[16:19], v[12:15]
  s_barrier
  s_waitcnt lgkmcnt(6)
  v_mfma_f32_32x32x16_bf16 v[64:79], v[32:35], v[40:43], v[64:79]
  ds_read_b64_tr_b16 v[16:17], v6 offset:16384
  v_mfma_f32_32x32x16_bf16 v[80:95], v[32:35], v[44:47], v[80:95]
  ds_read_b64_tr_b16 v[18:19], v6 offset:17408
  ds_read_b128 v[24:27], v4 offset:16384
  v_mfma_f32_32x32x16_bf16 v[96:111], v[36:39], v[40:43], v[96:111]
  ds_read_b128 v[28:31], v4 offset:18432
  v_mfma_f32_32x32x16_bf16 v[112:127], v[36:39], v[44:47], v[112:127]
  ds_read_b64_tr_b16 v[20:21], v7 offset:16384
  ds_read_b64_tr_b16 v[22:23], v7 offset:17408
  v_mfma_f32_16x16x32_bf16 v[12:15], v[8:11], v[32:35], v[12:15]
  s_waitcnt lgkmcnt(6)
  v_mfma_f32_32x32x16_bf16 v[64:79], v[48:51], v[56:59], v[64:79]
  ds_read_b64_tr_b16 v[32:33], v6 offset:20480
  v_mfma_f32_32x32x16_bf16 v[80:95], v[48:51], v[60:63], v[80:95]
  ds_read_b64_tr_b16 v[34:35], v6 offset:21504
  ds_read_b128 v[40:43], v5 offset:16384
  v_mfma_f32_32x32x16_bf16 v[96:111], v[52:55], v[56:59], v[96:111]
  ds_read_b128 v[44:47], v5 offset:18432
  v_mfma_f32_32x32x16_bf16 v[112:127], v[52:55], v[60:63], v[112:127]
  ds_read_b64_tr_b16 v[36:37], v7 offset:20480
  ds_read_b64_tr_b16 v[38:39], v7 offset:21504
  v_mfma_f32_16x16x32_bf16 v[12:15], v[8:11], v[48:51], v[12:15]
  s_barrier
  s_waitcnt lgkmcnt(6)
  v_mfma_f32_32x32x16_bf16 v[64:79], v[16:19], v[24:27], v[64:79]
  ds_read_b64_tr_b16 v[48:49], v6 offset:24576
  v_mfma_f32_32x32x16_bf16 v[80:95], v[16:19], v[28:31], v[80:95]
  ds_read_b64_tr_b16 v[50:51], v6 offset:25600
  ds_read_b128 v[56:59], v4 offset:24576
  v_mfma_f32_32x32x16_bf16 v[96:111], v[20:23], v[24:27], v[96:111]
  ds_read_b128 v[60:63], v4 offset:26624
  v_mfma_f32_32x32x16_bf16 v[112:127], v[20:23], v[28:31], v[112:127]
  ds_read_b64_tr_b16 v[52:53], v7 offset:24576
  ds_read_b64_tr_b16 v[54:55], v7 offset:25600
  v_mfma_f32_16x16x32_bf16 v[12:15], v[8:11], v[16:19], v[12:15]
  s_waitcnt lgkmcnt(6)
  v_mfma_f32_32x32x16_bf16 v[64:79], v[32:35], v[40:43], v[64:79]
  ds_read_b64_tr_b16 v[16:17], v6 offset:28672
  v_mfma_f32_32x32x16_bf16 v[80:95], v[32:35], v[44:47], v[80:95]
  ds_read_b64_tr_b16 v[18:19], v6 offset:29696
  ds_read_b128 v[24:27], v5 offset:24576
  v_mfma_f32_32x32x16_bf16 v[96:111], v[36:39], v[40:43], v[96:111]
  ds_read_b128 v[28:31], v5 offset:26624
  v_mfma_f32_32x32x16_bf16 v[112:127], v[36:39], v[44:47], v[112:127]
  ds_read_b64_tr_b16 v[20:21], v7 offset:28672
  ds_read_b64_tr_b16 v[22:23], v7 offset:29696
  v_mfma_f32_16x16x32_bf16 v[12:15], v[8:11], v[32:35], v[12:15]
  s_waitcnt lgkmcnt(6)
  v_mfma_f32_32x32x16_bf16 v[64:79], v[48:51], v[56:59], v[64:79]
  v_mfma_f32_32x32x16_bf16 v[80:95], v[48:51], v[60:63], v[80:95]
  v_mfma_f32_32x32x16_bf16 v[96:111], v[52:55], v[56:59], v[96:111]
  v_mfma_f32_32x32x16_bf16 v[112:127], v[52:55], v[60:63], v[112:127]
  v_mfma_f32_16x16x32_bf16 v[12:15], v[8:11], v[48:51], v[12:15]
  s_waitcnt lgkmcnt(0)
  v_mfma_f32_32x32x16_bf16 v[64:79], v[16:19], v[24:27], v[64:79]
  v_mfma_f32_32x32x16_bf16 v[80:95], v[16:19], v[28:31], v[80:95]
  v_mfma_f32_32x32x16_bf16 v[96:111], v[20:23], v[24:27], v[96:111]
  v_mfma_f32_32x32x16_bf16 v[112:127], v[20:23], v[28:31], v[112:127]
  v_mfma_f32_16x16x32_bf16 v[12:15], v[8:11], v[16:19], v[12:15]
  s_setprio 3
  v_and_b32 v3, 63, v0
  s_lshl_b32 s5, s68, 7
  v_and_b32 v2, 15, v3
  v_lshlrev_b32 v2, 2, v2
  v_add_u32 v2, s5, v2
  s_mov_b64 s[70:71], exec
  s_mov_b64 exec, 0xffff
  ds_write_b32 v2, v12 offset:32768
  ds_write_b32 v2, v13 offset:32832
  s_mov_b64 exec, s[70:71]
  s_waitcnt lgkmcnt(0)
  s_barrier
  v_lshrrev_b32 v2, 5, v3
  v_lshlrev_b32 v2, 4, v2
  s_lshl_b32 s5, s68, 7
  v_add_u32 v4, s5, v2
  s_lshl_b32 s5, s69, 7
  v_add_u32 v5, s5, v2
  v_and_b32 v2, 31, v3
  v_lshlrev_b32 v2, 3, v2
  s_lshl_b32 s5, s11, 9
  v_add_u32 v2, s5, v2
  ds_read_b64 v[48:49], v2 offset:33792
  ds_read_b64 v[50:51], v2 offset:34048
  ds_read_b128 v[16:19], v4 offset:32768
  ds_read_b128 v[20:23], v4 offset:32800
  ds_read_b128 v[24:27], v4 offset:32832
  ds_read_b128 v[28:31], v4 offset:32864
  ds_read_b128 v[32:35], v5 offset:32768
  ds_read_b128 v[36:39], v5 offset:32800
  ds_read_b128 v[40:43], v5 offset:32832
  ds_read_b128 v[44:47], v5 offset:32864
  s_lshl_b32 s4, s12, 2
  s_lshl_b32 s5, s11, 1
  s_add_u32 s4, s4, s5
  s_mul_i32 s4, s4, 112
  s_lshl_b32 s5, s13, 3
  s_add_u32 s4, s4, s5
  s_lshl_b32 s5, s68, 1
  s_add_u32 s74, s4, s5
  s_lshl_b32 s74, s74, 10
  s_lshl_b32 s5, s69, 1
  s_add_u32 s75, s4, s5
  s_lshl_b32 s75, s75, 10
  v_lshlrev_b32 v3, 4, v3
  s_waitcnt lgkmcnt(8)
  v_mul_f32 v48, v48, v49
  v_mul_f32 v50, v50, v51
  s_waitcnt lgkmcnt(0)
  v_mul_f32 v52, v16, v48
  v_fma_f32 v64, v64, v49, -v52
  v_mul_f32 v53, v17, v48
  v_fma_f32 v65, v65, v49, -v53
  v_mul_f32 v54, v18, v48
  v_fma_f32 v66, v66, v49, -v54
  v_mul_f32 v55, v19, v48
  v_fma_f32 v67, v67, v49, -v55
  v_mul_f32 v56, v20, v48
  v_fma_f32 v68, v68, v49, -v56
  v_mul_f32 v57, v21, v48
  v_fma_f32 v69, v69, v49, -v57
  v_mul_f32 v58, v22, v48
  v_fma_f32 v70, v70, v49, -v58
  v_mul_f32 v59, v23, v48
  v_fma_f32 v71, v71, v49, -v59
  v_mul_f32 v52, v24, v48
  v_fma_f32 v72, v72, v49, -v52
  v_mul_f32 v53, v25, v48
  v_fma_f32 v73, v73, v49, -v53
  v_mul_f32 v54, v26, v48
  v_fma_f32 v74, v74, v49, -v54
  v_mul_f32 v55, v27, v48
  v_fma_f32 v75, v75, v49, -v55
  v_mul_f32 v56, v28, v48
  v_fma_f32 v76, v76, v49, -v56
  v_mul_f32 v57, v29, v48
  v_fma_f32 v77, v77, v49, -v57
  v_mul_f32 v58, v30, v48
  v_fma_f32 v78, v78, v49, -v58
  v_mul_f32 v59, v31, v48
  v_fma_f32 v79, v79, v49, -v59
  v_max_f32 v64, 0, v64
  v_max_f32 v65, 0, v65
  v_cvt_pk_bf16_f32 v64, v64, v65
  v_max_f32 v66, 0, v66
  v_max_f32 v67, 0, v67
  v_cvt_pk_bf16_f32 v65, v66, v67
  v_max_f32 v68, 0, v68
  v_max_f32 v69, 0, v69
  v_cvt_pk_bf16_f32 v66, v68, v69
  v_max_f32 v70, 0, v70
  v_max_f32 v71, 0, v71
  v_cvt_pk_bf16_f32 v67, v70, v71
  v_max_f32 v72, 0, v72
  v_max_f32 v73, 0, v73
  v_cvt_pk_bf16_f32 v68, v72, v73
  v_max_f32 v74, 0, v74
  v_max_f32 v75, 0, v75
  v_cvt_pk_bf16_f32 v69, v74, v75
  v_max_f32 v76, 0, v76
  v_max_f32 v77, 0, v77
  v_cvt_pk_bf16_f32 v70, v76, v77
  v_max_f32 v78, 0, v78
  v_max_f32 v79, 0, v79
  v_cvt_pk_bf16_f32 v71, v78, v79
  s_add_u32 s5, s74, 0
  buffer_store_dwordx4 v[64:67], v3, s[56:59], s5 offen sc1
  buffer_store_dwordx4 v[68:71], v3, s[56:59], s5 offen offset:1024 sc1
  v_mul_f32 v52, v16, v50
  v_fma_f32 v80, v80, v51, -v52
  v_mul_f32 v53, v17, v50
  v_fma_f32 v81, v81, v51, -v53
  v_mul_f32 v54, v18, v50
  v_fma_f32 v82, v82, v51, -v54
  v_mul_f32 v55, v19, v50
  v_fma_f32 v83, v83, v51, -v55
  v_mul_f32 v56, v20, v50
  v_fma_f32 v84, v84, v51, -v56
  v_mul_f32 v57, v21, v50
  v_fma_f32 v85, v85, v51, -v57
  v_mul_f32 v58, v22, v50
  v_fma_f32 v86, v86, v51, -v58
  v_mul_f32 v59, v23, v50
  v_fma_f32 v87, v87, v51, -v59
  v_mul_f32 v52, v24, v50
  v_fma_f32 v88, v88, v51, -v52
  v_mul_f32 v53, v25, v50
  v_fma_f32 v89, v89, v51, -v53
  v_mul_f32 v54, v26, v50
  v_fma_f32 v90, v90, v51, -v54
  v_mul_f32 v55, v27, v50
  v_fma_f32 v91, v91, v51, -v55
  v_mul_f32 v56, v28, v50
  v_fma_f32 v92, v92, v51, -v56
  v_mul_f32 v57, v29, v50
  v_fma_f32 v93, v93, v51, -v57
  v_mul_f32 v58, v30, v50
  v_fma_f32 v94, v94, v51, -v58
  v_mul_f32 v59, v31, v50
  v_fma_f32 v95, v95, v51, -v59
  v_max_f32 v80, 0, v80
  v_max_f32 v81, 0, v81
  v_cvt_pk_bf16_f32 v80, v80, v81
  v_max_f32 v82, 0, v82
  v_max_f32 v83, 0, v83
  v_cvt_pk_bf16_f32 v81, v82, v83
  v_max_f32 v84, 0, v84
  v_max_f32 v85, 0, v85
  v_cvt_pk_bf16_f32 v82, v84, v85
  v_max_f32 v86, 0, v86
  v_max_f32 v87, 0, v87
  v_cvt_pk_bf16_f32 v83, v86, v87
  v_max_f32 v88, 0, v88
  v_max_f32 v89, 0, v89
  v_cvt_pk_bf16_f32 v84, v88, v89
  v_max_f32 v90, 0, v90
  v_max_f32 v91, 0, v91
  v_cvt_pk_bf16_f32 v85, v90, v91
  v_max_f32 v92, 0, v92
  v_max_f32 v93, 0, v93
  v_cvt_pk_bf16_f32 v86, v92, v93
  v_max_f32 v94, 0, v94
  v_max_f32 v95, 0, v95
  v_cvt_pk_bf16_f32 v87, v94, v95
  s_add_u32 s5, s74, 114688
  buffer_store_dwordx4 v[80:83], v3, s[56:59], s5 offen sc1
  buffer_store_dwordx4 v[84:87], v3, s[56:59], s5 offen offset:1024 sc1
  v_mul_f32 v52, v32, v48
  v_fma_f32 v96, v96, v49, -v52
  v_mul_f32 v53, v33, v48
  v_fma_f32 v97, v97, v49, -v53
  v_mul_f32 v54, v34, v48
  v_fma_f32 v98, v98, v49, -v54
  v_mul_f32 v55, v35, v48
  v_fma_f32 v99, v99, v49, -v55
  v_mul_f32 v56, v36, v48
  v_fma_f32 v100, v100, v49, -v56
  v_mul_f32 v57, v37, v48
  v_fma_f32 v101, v101, v49, -v57
  v_mul_f32 v58, v38, v48
  v_fma_f32 v102, v102, v49, -v58
  v_mul_f32 v59, v39, v48
  v_fma_f32 v103, v103, v49, -v59
  v_mul_f32 v52, v40, v48
  v_fma_f32 v104, v104, v49, -v52
  v_mul_f32 v53, v41, v48
  v_fma_f32 v105, v105, v49, -v53
  v_mul_f32 v54, v42, v48
  v_fma_f32 v106, v106, v49, -v54
  v_mul_f32 v55, v43, v48
  v_fma_f32 v107, v107, v49, -v55
  v_mul_f32 v56, v44, v48
  v_fma_f32 v108, v108, v49, -v56
  v_mul_f32 v57, v45, v48
  v_fma_f32 v109, v109, v49, -v57
  v_mul_f32 v58, v46, v48
  v_fma_f32 v110, v110, v49, -v58
  v_mul_f32 v59, v47, v48
  v_fma_f32 v111, v111, v49, -v59
  v_max_f32 v96, 0, v96
  v_max_f32 v97, 0, v97
  v_cvt_pk_bf16_f32 v96, v96, v97
  v_max_f32 v98, 0, v98
  v_max_f32 v99, 0, v99
  v_cvt_pk_bf16_f32 v97, v98, v99
  v_max_f32 v100, 0, v100
  v_max_f32 v101, 0, v101
  v_cvt_pk_bf16_f32 v98, v100, v101
  v_max_f32 v102, 0, v102
  v_max_f32 v103, 0, v103
  v_cvt_pk_bf16_f32 v99, v102, v103
  v_max_f32 v104, 0, v104
  v_max_f32 v105, 0, v105
  v_cvt_pk_bf16_f32 v100, v104, v105
  v_max_f32 v106, 0, v106
  v_max_f32 v107, 0, v107
  v_cvt_pk_bf16_f32 v101, v106, v107
  v_max_f32 v108, 0, v108
  v_max_f32 v109, 0, v109
  v_cvt_pk_bf16_f32 v102, v108, v109
  v_max_f32 v110, 0, v110
  v_max_f32 v111, 0, v111
  v_cvt_pk_bf16_f32 v103, v110, v111
  s_add_u32 s5, s75, 0
  buffer_store_dwordx4 v[96:99], v3, s[56:59], s5 offen sc1
  buffer_store_dwordx4 v[100:103], v3, s[56:59], s5 offen offset:1024 sc1
  v_mul_f32 v52, v32, v50
  v_fma_f32 v112, v112, v51, -v52
  v_mul_f32 v53, v33, v50
  v_fma_f32 v113, v113, v51, -v53
  v_mul_f32 v54, v34, v50
  v_fma_f32 v114, v114, v51, -v54
  v_mul_f32 v55, v35, v50
  v_fma_f32 v115, v115, v51, -v55
  v_mul_f32 v56, v36, v50
  v_fma_f32 v116, v116, v51, -v56
  v_mul_f32 v57, v37, v50
  v_fma_f32 v117, v117, v51, -v57
  v_mul_f32 v58, v38, v50
  v_fma_f32 v118, v118, v51, -v58
  v_mul_f32 v59, v39, v50
  v_fma_f32 v119, v119, v51, -v59
  v_mul_f32 v52, v40, v50
  v_fma_f32 v120, v120, v51, -v52
  v_mul_f32 v53, v41, v50
  v_fma_f32 v121, v121, v51, -v53
  v_mul_f32 v54, v42, v50
  v_fma_f32 v122, v122, v51, -v54
  v_mul_f32 v55, v43, v50
  v_fma_f32 v123, v123, v51, -v55
  v_mul_f32 v56, v44, v50
  v_fma_f32 v124, v124, v51, -v56
  v_mul_f32 v57, v45, v50
  v_fma_f32 v125, v125, v51, -v57
  v_mul_f32 v58, v46, v50
  v_fma_f32 v126, v126, v51, -v58
  v_mul_f32 v59, v47, v50
  v_fma_f32 v127, v127, v51, -v59
  v_max_f32 v112, 0, v112
  v_max_f32 v113, 0, v113
  v_cvt_pk_bf16_f32 v112, v112, v113
  v_max_f32 v114, 0, v114
  v_max_f32 v115, 0, v115
  v_cvt_pk_bf16_f32 v113, v114, v115
  v_max_f32 v116, 0, v116
  v_max_f32 v117, 0, v117
  v_cvt_pk_bf16_f32 v114, v116, v117
  v_max_f32 v118, 0, v118
  v_max_f32 v119, 0, v119
  v_cvt_pk_bf16_f32 v115, v118, v119
  v_max_f32 v120, 0, v120
  v_max_f32 v121, 0, v121
  v_cvt_pk_bf16_f32 v116, v120, v121
  v_max_f32 v122, 0, v122
  v_max_f32 v123, 0, v123
  v_cvt_pk_bf16_f32 v117, v122, v123
  v_max_f32 v124, 0, v124
  v_max_f32 v125, 0, v125
  v_cvt_pk_bf16_f32 v118, v124, v125
  v_max_f32 v126, 0, v126
  v_max_f32 v127, 0, v127
  v_cvt_pk_bf16_f32 v119, v126, v127
  s_add_u32 s5, s75, 114688
  buffer_store_dwordx4 v[112:115], v3, s[56:59], s5 offen sc1
  buffer_store_dwordx4 v[116:119], v3, s[56:59], s5 offen offset:1024 sc1
  s_setprio 0
  s_waitcnt vmcnt(0)
L_g1_done:
  s_barrier
  s_cmp_eq_u32 s7, 7
  s_cbranch_scc0 L_g1pub_5
  v_mov_b32 v4, 0
  v_mov_b32 v5, s46
  s_mov_b64 s[86:87], exec
  s_mov_b64 exec, 1
  buffer_store_dword v5, v4, s[80:83], s92 offen sc1
  s_mov_b64 exec, s[86:87]
L_g1pub_5:
  s_cmp_eq_u32 s91, 0
  s_cbranch_scc0 L_g2su_6
  s_add_u32 s48, s44, 0x700000
  s_addc_u32 s49, s45, 0
  s_mov_b32 s50, 0x188000
  s_mov_b32 s51, 0x00020000
  s_mov_b32 s52, s44
  s_mov_b32 s53, s45
  s_mov_b32 s54, 0x700000
  s_mov_b32 s55, 0x00020000
  s_lshr_b32 s14, s3, 3
  s_mul_hi_u32 s5, s14, 0x24924925
  s_mul_i32 s13, s5, 7
  s_sub_u32 s13, s14, s13
  s_and_b32 s12, s3, 7
  s_lshl_b32 s12, s12, 2
  s_add_u32 s12, s12, s5
  v_and_b32 v2, 63, v0
  v_lshlrev_b32 v3, 4, v2
  s_mul_i32 s4, s7, 14
  s_lshl_b32 s5, s13, 1
  s_mul_i32 s5, s5, 112
  s_add_u32 s5, s5, s4
  s_lshl_b32 s68, s5, 10
  s_add_u32 s69, s68, 114688
  s_lshl_b32 s5, s12, 1
  s_mul_i32 s5, s5, 112
  s_add_u32 s5, s5, s4
  s_lshl_b32 s70, s5, 10
  s_add_u32 s71, s70, 114688
  v_mov_b32 v64, 0
  v_mov_b32 v65, 0
  v_mov_b32 v66, 0
  v_mov_b32 v67, 0
  v_mov_b32 v68, 0
  v_mov_b32 v69, 0
  v_mov_b32 v70, 0
  v_mov_b32 v71, 0
  v_mov_b32 v72, 0
  v_mov_b32 v73, 0
  v_mov_b32 v74, 0
  v_mov_b32 v75, 0
  v_mov_b32 v76, 0
  v_mov_b32 v77, 0
  v_mov_b32 v78, 0
  v_mov_b32 v79, 0
  v_mov_b32 v80, 0
  v_mov_b32 v81, 0
  v_mov_b32 v82, 0
  v_mov_b32 v83, 0
  v_mov_b32 v84, 0
  v_mov_b32 v85, 0
  v_mov_b32 v86, 0
  v_mov_b32 v87, 0
  v_mov_b32 v88, 0
  v_mov_b32 v89, 0
  v_mov_b32 v90, 0
  v_mov_b32 v91, 0
  v_mov_b32 v92, 0
  v_mov_b32 v93, 0
  v_mov_b32 v94, 0
  v_mov_b32 v95, 0
  v_mov_b32 v96, 0
  v_mov_b32 v97, 0
  v_mov_b32 v98, 0
  v_mov_b32 v99, 0
  v_mov_b32 v100, 0
  v_mov_b32 v101, 0
  v_mov_b32 v102, 0
  v_mov_b32 v103, 0
  v_mov_b32 v104, 0
  v_mov_b32 v105, 0
  v_mov_b32 v106, 0
  v_mov_b32 v107, 0
  v_mov_b32 v108, 0
  v_mov_b32 v109, 0
  v_mov_b32 v110, 0
  v_mov_b32 v111, 0
  v_mov_b32 v112, 0
  v_mov_b32 v113, 0
  v_mov_b32 v114, 0
  v_mov_b32 v115, 0
  v_mov_b32 v116, 0
  v_mov_b32 v117, 0
  v_mov_b32 v118, 0
  v_mov_b32 v119, 0
  v_mov_b32 v120, 0
  v_mov_b32 v121, 0
  v_mov_b32 v122, 0
  v_mov_b32 v123, 0
  v_mov_b32 v124, 0
  v_mov_b32 v125, 0
  v_mov_b32 v126, 0
  v_mov_b32 v127, 0
  s_mul_i32 s90, s7, 10240
L_g2su_6:
  s_mov_b32 s9, 36864
  s_cmp_eq_u32 s7, 4
  s_cbranch_scc0 L_wgw_7
  s_cmp_eq_u32 s91, 2
  s_cbranch_scc1 L_fwk_8
  v_and_b32 v4, 63, v0
  v_lshlrev_b32 v4, 4, v4
  s_mov_b64 s[86:87], exec
  s_mov_b32 exec_lo, 0xffffffff
  s_mov_b32 exec_hi, 0xffffff
  s_mov_b32 s77, 0
L_wf_9:
  buffer_load_dwordx4 v[8:11], v4, s[80:83], s9 offen sc1
  s_waitcnt vmcnt(0)
  v_cmp_ne_u32 vcc, s46, v8
  v_cmp_ne_u32 s[88:89], s46, v9
  s_nop 0
  s_or_b64 vcc, vcc, s[88:89]
  v_cmp_ne_u32 s[88:89], s46, v10
  s_nop 0
  s_or_b64 vcc, vcc, s[88:89]
  v_cmp_ne_u32 s[88:89], s46, v11
  s_nop 0
  s_or_b64 vcc, vcc, s[88:89]
  s_cbranch_vccz L_wfok_10
  s_add_u32 s77, s77, 1
  s_cmp_ge_u32 s77, 0x80000
  s_cbranch_scc1 L_wfok_10
  s_sleep 8
  s_branch L_wf_9
L_wfok_10:
  s_mov_b64 exec, s[86:87]
L_fwk_8:
L_wgw_7:
  s_barrier
  s_lshr_b32 s9, s12, 1
  s_mul_i32 s9, s9, 1792
  s_add_u32 s9, s9, 8192
  s_mul_i32 s4, s7, 7
  s_lshr_b32 s4, s4, 2
  s_mul_i32 s6, s7, 224
  s_add_u32 s6, s6, 223
  s_lshr_b32 s6, s6, 7
  v_add_u32 v4, s4, v2
  v_min_u32 v4, s6, v4
  v_lshlrev_b32 v4, 7, v4
  s_mov_b64 s[86:87], exec
  s_mov_b64 exec, 7
  buffer_load_dword v8, v4, s[80:83], s9 offen sc1
  s_mov_b64 exec, s[86:87]
  s_cmp_eq_u32 s91, 2
  s_cbranch_scc1 L_g2p1_11
  s_add_u32 m0, s90, 0
  s_nop 0
  buffer_load_dwordx4 v3, s[48:51], s68 offen sc1 lds
  s_add_u32 s68, s68, 1024
  s_add_u32 m0, s90, 1024
  s_nop 0
  buffer_load_dwordx4 v3, s[48:51], s69 offen sc1 lds
  s_add_u32 s69, s69, 1024
  s_add_u32 m0, s90, 2048
  s_nop 0
  buffer_load_dwordx4 v3, s[48:51], s68 offen sc1 lds
  s_add_u32 s68, s68, 1024
  s_add_u32 m0, s90, 3072
  s_nop 0
  buffer_load_dwordx4 v3, s[48:51], s69 offen sc1 lds
  s_add_u32 s69, s69, 1024
  s_add_u32 m0, s90, 4096
  s_nop 0
  buffer_load_dwordx4 v3, s[48:51], s68 offen sc1 lds
  s_add_u32 s68, s68, 1024
  s_add_u32 m0, s90, 5120
  s_nop 0
  buffer_load_dwordx4 v3, s[48:51], s69 offen sc1 lds
  s_add_u32 s69, s69, 1024
  s_add_u32 m0, s90, 6144
  s_nop 0
  buffer_load_dwordx4 v3, s[48:51], s68 offen sc1 lds
  s_add_u32 s68, s68, 1024
  s_add_u32 m0, s90, 7168
  s_nop 0
  buffer_load_dwordx4 v3, s[48:51], s69 offen sc1 lds
  s_add_u32 s69, s69, 1024
  s_add_u32 m0, s90, 8192
  s_nop 0
  buffer_load_dwordx4 v3, s[48:51], s68 offen sc1 lds
  s_add_u32 s68, s68, 1024
  s_add_u32 m0, s90, 9216
  s_nop 0
  buffer_load_dwordx4 v3, s[48:51], s69 offen sc1 lds
  s_add_u32 s69, s69, 1024
  s_waitcnt vmcnt(10)
  s_branch L_g2p2_12
L_g2p1_11:
  s_waitcnt vmcnt(0)
L_g2p2_12:
  v_add_u32 v14, s90, v3
  s_mov_b64 exec, 7
  s_mov_b32 s77, 0
L_wh_13:
  v_cmp_ne_u32 vcc, s46, v8
  s_nop 4
  s_cbranch_vccz L_whok_14
  s_add_u32 s77, s77, 1
  s_cmp_ge_u32 s77, 0x80000
  s_cbranch_scc1 L_whok_14
  s_sleep 4
  buffer_load_dword v8, v4, s[80:83], s9 offen sc1
  s_waitcnt vmcnt(0)
  s_branch L_wh_13
L_whok_14:
  s_mov_b64 exec, s[86:87]
  buffer_load_dwordx4 v[32:35], v3, s[52:55], s70 offen offset:0 sc1
  buffer_load_dwordx4 v[36:39], v3, s[52:55], s71 offen offset:0 sc1
  buffer_load_dwordx4 v[40:43], v3, s[52:55], s70 offen offset:1024 sc1
  buffer_load_dwordx4 v[44:47], v3, s[52:55], s71 offen offset:1024 sc1
  buffer_load_dwordx4 v[48:51], v3, s[52:55], s70 offen offset:2048 sc1
  buffer_load_dwordx4 v[52:55], v3, s[52:55], s71 offen offset:2048 sc1
  buffer_load_dwordx4 v[56:59], v3, s[52:55], s70 offen offset:3072 sc1
  buffer_load_dwordx4 v[60:63], v3, s[52:55], s71 offen offset:3072 sc1
  s_add_u32 s70, s70, 4096
  s_add_u32 s71, s71, 4096
  s_waitcnt vmcnt(16)
  ds_read_b128 v[16:19], v14 offset:0
  ds_read_b128 v[20:23], v14 offset:1024
  s_add_u32 s56, s44, 0x1100000
  s_addc_u32 s57, s45, 0
  s_mov_b32 s58, 0x1c0000
  s_mov_b32 s59, 0x00020000
  s_mov_b32 s60, s16
  s_mov_b32 s61, s17
  s_mov_b32 s62, 0x1c0000
  s_mov_b32 s63, 0x00020000
  s_mov_b32 s64, s40
  s_mov_b32 s65, s41
  s_mov_b32 s66, 0x1c0000
  s_mov_b32 s67, 0x00020000
  s_lshr_b32 s8, s7, 2
  s_bfe_u32 s9, s7, 0x10001
  s_and_b32 s15, s7, 1
  s_lshl_b32 s4, s12, 6
  s_lshl_b32 s5, s9, 5
  s_add_u32 s4, s4, s5
  s_lshl_b32 s5, s13, 6
  s_lshl_b32 s6, s8, 5
  s_add_u32 s5, s5, s6
  s_lshl_b32 s6, s15, 4
  s_add_u32 s5, s5, s6
  s_mul_i32 s10, s4, 896
  s_lshl_b32 s6, s5, 1
  s_add_u32 s10, s10, s6
  s_lshl_b32 s11, s5, 12
  s_lshl_b32 s6, s4, 1
  s_add_u32 s11, s11, s6
  v_and_b32 v4, 31, v2
  v_lshrrev_b32 v5, 5, v2
  v_mul_u32_u24 v6, 896, v4
  v_lshl_add_u32 v6, v5, 3, v6
  v_lshlrev_b32 v7, 14, v5
  v_lshl_add_u32 v7, v4, 1, v7
  buffer_load_dwordx2 v[8:9], v6, s[60:63], s10 offen offset:0
  buffer_load_dwordx2 v[10:11], v6, s[60:63], s10 offen offset:16
  s_waitcnt vmcnt(8) lgkmcnt(0)
  v_mfma_f32_32x32x16_bf16 v[64:79], v[16:19], v[32:35], v[64:79]
  ds_read_b128 v[24:27], v14 offset:2048
  v_mfma_f32_32x32x16_bf16 v[80:95], v[16:19], v[36:39], v[80:95]
  ds_read_b128 v[28:31], v14 offset:3072
  v_mfma_f32_32x32x16_bf16 v[96:111], v[20:23], v[32:35], v[96:111]
  buffer_load_dwordx4 v[32:35], v3, s[52:55], s70 offen offset:0 sc1
  s_add_u32 m0, s90, 0
  s_nop 0
  buffer_load_dwordx4 v3, s[48:51], s68 offen sc1 lds
  s_add_u32 s68, s68, 1024
  v_mfma_f32_32x32x16_bf16 v[112:127], v[20:23], v[36:39], v[112:127]
  buffer_load_dwordx4 v[36:39], v3, s[52:55], s71 offen offset:0 sc1
  s_add_u32 m0, s90, 1024
  s_nop 0
  buffer_load_dwordx4 v3, s[48:51], s69 offen sc1 lds
  s_add_u32 s69, s69, 1024
  s_waitcnt vmcnt(10) lgkmcnt(0)
  v_mfma_f32_32x32x16_bf16 v[64:79], v[24:27], v[40:43], v[64:79]
  ds_read_b128 v[16:19], v14 offset:4096
  v_mfma_f32_32x32x16_bf16 v[80:95], v[24:27], v[44:47], v[80:95]
  ds_read_b128 v[20:23], v14 offset:5120
  v_mfma_f32_32x32x16_bf16 v[96:111], v[28:31], v[40:43], v[96:111]
  buffer_load_dwordx4 v[40:43], v3, s[52:55], s70 offen offset:1024 sc1
  s_add_u32 m0, s90, 2048
  s_nop 0
  buffer_load_dwordx4 v3, s[48:51], s68 offen sc1 lds
  s_add_u32 s68, s68, 1024
  v_mfma_f32_32x32x16_bf16 v[112:127], v[28:31], v[44:47], v[112:127]
  buffer_load_dwordx4 v[44:47], v3, s[52:55], s71 offen offset:1024 sc1
  s_add_u32 m0, s90, 3072
  s_nop 0
  buffer_load_dwordx4 v3, s[48:51], s69 offen sc1 lds
  s_add_u32 s69, s69, 1024
  s_waitcnt vmcnt(12) lgkmcnt(0)
  v_mfma_f32_32x32x16_bf16 v[64:79], v[16:19], v[48:51], v[64:79]
  ds_read_b128 v[24:27], v14 offset:6144
  v_mfma_f32_32x32x16_bf16 v[80:95], v[16:19], v[52:55], v[80:95]
  ds_read_b128 v[28:31], v14 offset:7168
  v_mfma_f32_32x32x16_bf16 v[96:111], v[20:23], v[48:51], v[96:111]
  buffer_load_dwordx4 v[48:51], v3, s[52:55], s70 offen offset:2048 sc1
  s_add_u32 m0, s90, 4096
  s_nop 0
  buffer_load_dwordx4 v3, s[48:51], s68 offen sc1 lds
  s_add_u32 s68, s68, 1024
  v_mfma_f32_32x32x16_bf16 v[112:127], v[20:23], v[52:55], v[112:127]
  buffer_load_dwordx4 v[52:55], v3, s[52:55], s71 offen offset:2048 sc1
  s_add_u32 m0, s90, 5120
  s_nop 0
  buffer_load_dwordx4 v3, s[48:51], s69 offen sc1 lds
  s_add_u32 s69, s69, 1024
  s_waitcnt vmcnt(14) lgkmcnt(0)
  v_mfma_f32_32x32x16_bf16 v[64:79], v[24:27], v[56:59], v[64:79]
  ds_read_b128 v[16:19], v14 offset:8192
  v_mfma_f32_32x32x16_bf16 v[80:95], v[24:27], v[60:63], v[80:95]
  ds_read_b128 v[20:23], v14 offset:9216
  v_mfma_f32_32x32x16_bf16 v[96:111], v[28:31], v[56:59], v[96:111]
  buffer_load_dwordx4 v[56:59], v3, s[52:55], s70 offen offset:3072 sc1
  s_add_u32 m0, s90, 6144
  s_nop 0
  buffer_load_dwordx4 v3, s[48:51], s68 offen sc1 lds
  s_add_u32 s68, s68, 1024
  v_mfma_f32_32x32x16_bf16 v[112:127], v[28:31], v[60:63], v[112:127]
  buffer_load_dwordx4 v[60:63], v3, s[52:55], s71 offen offset:3072 sc1
  s_add_u32 s70, s70, 4096
  s_add_u32 s71, s71, 4096
  s_add_u32 m0, s90, 7168
  s_nop 0
  buffer_load_dwordx4 v3, s[48:51], s69 offen sc1 lds
  s_add_u32 s69, s69, 1024
  s_waitcnt vmcnt(12) lgkmcnt(0)
  v_mfma_f32_32x32x16_bf16 v[64:79], v[16:19], v[32:35], v[64:79]
  ds_read_b128 v[24:27], v14 offset:0
  v_mfma_f32_32x32x16_bf16 v[80:95], v[16:19], v[36:39], v[80:95]
  ds_read_b128 v[28:31], v14 offset:1024
  v_mfma_f32_32x32x16_bf16 v[96:111], v[20:23], v[32:35], v[96:111]
  buffer_load_dwordx4 v[32:35], v3, s[52:55], s70 offen offset:0 sc1
  s_add_u32 m0, s90, 8192
  s_nop 0
  buffer_load_dwordx4 v3, s[48:51], s68 offen sc1 lds
  s_add_u32 s68, s68, 1024
  v_mfma_f32_32x32x16_bf16 v[112:127], v[20:23], v[36:39], v[112:127]
  buffer_load_dwordx4 v[36:39], v3, s[52:55], s71 offen offset:0 sc1
  s_add_u32 m0, s90, 9216
  s_nop 0
  buffer_load_dwordx4 v3, s[48:51], s69 offen sc1 lds
  s_add_u32 s69, s69, 1024
  s_waitcnt vmcnt(12) lgkmcnt(0)
  v_mfma_f32_32x32x16_bf16 v[64:79], v[24:27], v[40:43], v[64:79]
  ds_read_b128 v[16:19], v14 offset:2048
  v_mfma_f32_32x32x16_bf16 v[80:95], v[24:27], v[44:47], v[80:95]
  ds_read_b128 v[20:23], v14 offset:3072
  v_mfma_f32_32x32x16_bf16 v[96:111], v[28:31], v[40:43], v[96:111]
  buffer_load_dwordx4 v[40:43], v3, s[52:55], s70 offen offset:1024 sc1
  s_add_u32 m0, s90, 0
  s_nop 0
  buffer_load_dwordx4 v3, s[48:51], s68 offen sc1 lds
  s_add_u32 s68, s68, 1024
  v_mfma_f32_32x32x16_bf16 v[112:127], v[28:31], v[44:47], v[112:127]
  buffer_load_dwordx4 v[44:47], v3, s[52:55], s71 offen offset:1024 sc1
  s_add_u32 m0, s90, 1024
  s_nop 0
  buffer_load_dwordx4 v3, s[48:51], s69 offen sc1 lds
  s_add_u32 s69, s69, 1024
  s_waitcnt vmcnt(12) lgkmcnt(0)
  v_mfma_f32_32x32x16_bf16 v[64:79], v[16:19], v[48:51], v[64:79]
  ds_read_b128 v[24:27], v14 offset:4096
  v_mfma_f32_32x32x16_bf16 v[80:95], v[16:19], v[52:55], v[80:95]
  ds_read_b128 v[28:31], v14 offset:5120
  v_mfma_f32_32x32x16_bf16 v[96:111], v[20:23], v[48:51], v[96:111]
  buffer_load_dwordx4 v[48:51], v3, s[52:55], s70 offen offset:2048 sc1
  s_add_u32 m0, s90, 2048
  s_nop 0
  buffer_load_dwordx4 v3, s[48:51], s68 offen sc1 lds
  s_add_u32 s68, s68, 1024
  v_mfma_f32_32x32x16_bf16 v[112:127], v[20:23], v[52:55], v[112:127]
  buffer_load_dwordx4 v[52:55], v3, s[52:55], s71 offen offset:2048 sc1
  s_add_u32 m0, s90, 3072
  s_nop 0
  buffer_load_dwordx4 v3, s[48:51], s69 offen sc1 lds
  s_add_u32 s69, s69, 1024
  s_waitcnt vmcnt(12) lgkmcnt(0)
  v_mfma_f32_32x32x16_bf16 v[64:79], v[24:27], v[56:59], v[64:79]
  ds_read_b128 v[16:19], v14 offset:6144
  v_mfma_f32_32x32x16_bf16 v[80:95], v[24:27], v[60:63], v[80:95]
  ds_read_b128 v[20:23], v14 offset:7168
  v_mfma_f32_32x32x16_bf16 v[96:111], v[28:31], v[56:59], v[96:111]
  buffer_load_dwordx4 v[56:59], v3, s[52:55], s70 offen offset:3072 sc1
  s_add_u32 m0, s90, 4096
  s_nop 0
  buffer_load_dwordx4 v3, s[48:51], s68 offen sc1 lds
  s_add_u32 s68, s68, 1024
  v_mfma_f32_32x32x16_bf16 v[112:127], v[28:31], v[60:63], v[112:127]
  buffer_load_dwordx4 v[60:63], v3, s[52:55], s71 offen offset:3072 sc1
  s_add_u32 s70, s70, 4096
  s_add_u32 s71, s71, 4096
  s_add_u32 m0, s90, 5120
  s_nop 0
  buffer_load_dwordx4 v3, s[48:51], s69 offen sc1 lds
  s_add_u32 s69, s69, 1024
  s_waitcnt vmcnt(12) lgkmcnt(0)
  v_mfma_f32_32x32x16_bf16 v[64:79], v[16:19], v[32:35], v[64:79]
  ds_read_b128 v[24:27], v14 offset:8192
  v_mfma_f32_32x32x16_bf16 v[80:95], v[16:19], v[36:39], v[80:95]
  ds_read_b128 v[28:31], v14 offset:9216
  v_mfma_f32_32x32x16_bf16 v[96:111], v[20:23], v[32:35], v[96:111]
  buffer_load_dwordx4 v[32:35], v3, s[52:55], s70 offen offset:0 sc1
  s_add_u32 m0, s90, 6144
  s_nop 0
  buffer_load_dwordx4 v3, s[48:51], s68 offen sc1 lds
  s_add_u32 s68, s68, 1024
  v_mfma_f32_32x32x16_bf16 v[112:127], v[20:23], v[36:39], v[112:127]
  buffer_load_dwordx4 v[36:39], v3, s[52:55], s71 offen offset:0 sc1
  s_add_u32 m0, s90, 7168
  s_nop 0
  buffer_load_dwordx4 v3, s[48:51], s69 offen sc1 lds
  s_add_u32 s69, s69, 1024
  s_waitcnt vmcnt(12) lgkmcnt(0)
  v_mfma_f32_32x32x16_bf16 v[64:79], v[24:27], v[40:43], v[64:79]
  ds_read_b128 v[16:19], v14 offset:0
  v_mfma_f32_32x32x16_bf16 v[80:95], v[24:27], v[44:47], v[80:95]
  ds_read_b128 v[20:23], v14 offset:1024
  v_mfma_f32_32x32x16_bf16 v[96:111], v[28:31], v[40:43], v[96:111]
  buffer_load_dwordx4 v[40:43], v3, s[52:55], s70 offen offset:1024 sc1
  v_mfma_f32_32x32x16_bf16 v[112:127], v[28:31], v[44:47], v[112:127]
  buffer_load_dwordx4 v[44:47], v3, s[52:55], s71 offen offset:1024 sc1
  s_waitcnt vmcnt(10) lgkmcnt(0)
  v_mfma_f32_32x32x16_bf16 v[64:79], v[16:19], v[48:51], v[64:79]
  ds_read_b128 v[24:27], v14 offset:2048
  v_mfma_f32_32x32x16_bf16 v[80:95], v[16:19], v[52:55], v[80:95]
  ds_read_b128 v[28:31], v14 offset:3072
  v_mfma_f32_32x32x16_bf16 v[96:111], v[20:23], v[48:51], v[96:111]
  v_mfma_f32_32x32x16_bf16 v[112:127], v[20:23], v[52:55], v[112:127]
  s_waitcnt vmcnt(6) lgkmcnt(0)
  v_mfma_f32_32x32x16_bf16 v[64:79], v[24:27], v[56:59], v[64:79]
  ds_read_b128 v[16:19], v14 offset:4096
  v_mfma_f32_32x32x16_bf16 v[80:95], v[24:27], v[60:63], v[80:95]
  ds_read_b128 v[20:23], v14 offset:5120
  v_mfma_f32_32x32x16_bf16 v[96:111], v[28:31], v[56:59], v[96:111]
  v_mfma_f32_32x32x16_bf16 v[112:127], v[28:31], v[60:63], v[112:127]
  s_waitcnt vmcnt(2) lgkmcnt(0)
  v_mfma_f32_32x32x16_bf16 v[64:79], v[16:19], v[32:35], v[64:79]
  ds_read_b128 v[24:27], v14 offset:6144
  v_mfma_f32_32x32x16_bf16 v[80:95], v[16:19], v[36:39], v[80:95]
  ds_read_b128 v[28:31], v14 offset:7168
  v_mfma_f32_32x32x16_bf16 v[96:111], v[20:23], v[32:35], v[96:111]
  v_mfma_f32_32x32x16_bf16 v[112:127], v[20:23], v[36:39], v[112:127]
  s_waitcnt vmcnt(0) lgkmcnt(0)
  v_mfma_f32_32x32x16_bf16 v[64:79], v[24:27], v[40:43], v[64:79]
  v_mfma_f32_32x32x16_bf16 v[80:95], v[24:27], v[44:47], v[80:95]
  v_mfma_f32_32x32x16_bf16 v[96:111], v[28:31], v[40:43], v[96:111]
  v_mfma_f32_32x32x16_bf16 v[112:127], v[28:31], v[44:47], v[112:127]
  s_lshl_b32 s5, s13, 7
  s_and_b32 s6, s2, 7
  s_lshl_b32 s6, s6, 10
  s_add_u32 s5, s5, s6
  s_add_u32 s5, s5, 98304
  s_cmp_eq_u32 s7, 0
  s_cbranch_scc0 L_g2c_15
  v_and_b32 v12, 63, v0
  v_lshlrev_b32 v12, 2, v12
  s_mov_b64 s[86:87], exec
  s_mov_b32 exec_lo, 0xffffffff
  s_mov_b32 exec_hi, 0x0
  s_mov_b32 s77, 0
L_wf_16:
  buffer_load_dword v13, v12, s[80:83], s5 offen offset:0 sc1
  s_waitcnt vmcnt(0)
  v_cmp_ne_u32 vcc, s46, v13
  s_nop 4
  s_cbranch_vccz L_wfok_17
  s_add_u32 s77, s77, 1
  s_cmp_ge_u32 s77, 0x80000
  s_cbranch_scc1 L_wfok_17
  s_sleep 8
  s_branch L_wf_16
L_wfok_17:
  s_mov_b64 exec, s[86:87]
L_g2c_15:
  s_mul_i32 s4, s7, 10240
  v_add_u32 v12, s4, v3
  s_cmp_eq_u32 s8, 0
  s_cbranch_scc0 L_g2r_18
  ds_write_b128 v12, v[96:99] offset:0
  ds_write_b128 v12, v[100:103] offset:1024
  ds_write_b128 v12, v[104:107] offset:2048
  ds_write_b128 v12, v[108:111] offset:3072
  ds_write_b128 v12, v[112:115] offset:4096
  ds_write_b128 v12, v[116:119] offset:5120
  ds_write_b128 v12, v[120:123] offset:6144
  ds_write_b128 v12, v[124:127] offset:7168
  s_branch L_g2re_19
L_g2r_18:
  ds_write_b128 v12, v[64:67] offset:0
  ds_write_b128 v12, v[68:71] offset:1024
  ds_write_b128 v12, v[72:75] offset:2048
  ds_write_b128 v12, v[76:79] offset:3072
  ds_write_b128 v12, v[80:83] offset:4096
  ds_write_b128 v12, v[84:87] offset:5120
  ds_write_b128 v12, v[88:91] offset:6144
  ds_write_b128 v12, v[92:95] offset:7168
  v_mov_b32 v64, v96
  v_mov_b32 v65, v97
  v_mov_b32 v66, v98
  v_mov_b32 v67, v99
  v_mov_b32 v68, v100
  v_mov_b32 v69, v101
  v_mov_b32 v70, v102
  v_mov_b32 v71, v103
  v_mov_b32 v72, v104
  v_mov_b32 v73, v105
  v_mov_b32 v74, v106
  v_mov_b32 v75, v107
  v_mov_b32 v76, v108
  v_mov_b32 v77, v109
  v_mov_b32 v78, v110
  v_mov_b32 v79, v111
  v_mov_b32 v80, v112
  v_mov_b32 v81, v113
  v_mov_b32 v82, v114
  v_mov_b32 v83, v115
  v_mov_b32 v84, v116
  v_mov_b32 v85, v117
  v_mov_b32 v86, v118
  v_mov_b32 v87, v119
  v_mov_b32 v88, v120
  v_mov_b32 v89, v121
  v_mov_b32 v90, v122
  v_mov_b32 v91, v123
  v_mov_b32 v92, v124
  v_mov_b32 v93, v125
  v_mov_b32 v94, v126
  v_mov_b32 v95, v127
L_g2re_19:
  s_xor_b32 s4, s7, 4
  s_mul_i32 s4, s4, 10240
  v_add_u32 v12, s4, v3
  s_waitcnt lgkmcnt(0)
  s_barrier
  s_add_u32 s6, s11, 0
  buffer_load_ushort v16, v7, s[56:59], s6 offen sc1
  s_add_u32 s6, s11, 4096
  buffer_load_ushort v17, v7, s[56:59], s6 offen sc1
  s_add_u32 s6, s11, 8192
  buffer_load_ushort v18, v7, s[56:59], s6 offen sc1
  s_add_u32 s6, s11, 12288
  buffer_load_ushort v19, v7, s[56:59], s6 offen sc1
  s_add_u32 s6, s11, 32768
  buffer_load_ushort v20, v7, s[56:59], s6 offen sc1
  s_add_u32 s6, s11, 36864
  buffer_load_ushort v21, v7, s[56:59], s6 offen sc1
  s_add_u32 s6, s11, 40960
  buffer_load_ushort v22, v7, s[56:59], s6 offen sc1
  s_add_u32 s6, s11, 45056
  buffer_load_ushort v23, v7, s[56:59], s6 offen sc1
  ds_read_b128 v[96:99], v12 offset:0
  ds_read_b128 v[100:103], v12 offset:1024
  ds_read_b128 v[104:107], v12 offset:2048
  ds_read_b128 v[108:111], v12 offset:3072
  ds_read_b128 v[112:115], v12 offset:4096
  ds_read_b128 v[116:119], v12 offset:5120
  ds_read_b128 v[120:123], v12 offset:6144
  ds_read_b128 v[124:127], v12 offset:7168
  s_waitcnt lgkmcnt(7)
  v_add_f32 v64, v64, v96
  v_add_f32 v65, v65, v97
  v_add_f32 v66, v66, v98
  v_add_f32 v67, v67, v99
  s_waitcnt lgkmcnt(6)
  v_add_f32 v68, v68, v100
  v_add_f32 v69, v69, v101
  v_add_f32 v70, v70, v102
  v_add_f32 v71, v71, v103
  s_waitcnt lgkmcnt(5)
  v_add_f32 v72, v72, v104
  v_add_f32 v73, v73, v105
  v_add_f32 v74, v74, v106
  v_add_f32 v75, v75, v107
  s_waitcnt lgkmcnt(4)
  v_add_f32 v76, v76, v108
  v_add_f32 v77, v77, v109
  v_add_f32 v78, v78, v110
  v_add_f32 v79, v79, v111
  s_waitcnt lgkmcnt(3)
  v_add_f32 v80, v80, v112
  v_add_f32 v81, v81, v113
  v_add_f32 v82, v82, v114
  v_add_f32 v83, v83, v115
  s_waitcnt lgkmcnt(2)
  v_add_f32 v84, v84, v116
  v_add_f32 v85, v85, v117
  v_add_f32 v86, v86, v118
  v_add_f32 v87, v87, v119
  s_waitcnt lgkmcnt(1)
  v_add_f32 v88, v88, v120
  v_add_f32 v89, v89, v121
  v_add_f32 v90, v90, v122
  v_add_f32 v91, v91, v123
  s_waitcnt lgkmcnt(0)
  v_add_f32 v92, v92, v124
  v_add_f32 v93, v93, v125
  v_add_f32 v94, v94, v126
  v_add_f32 v95, v95, v127
  s_barrier
  s_and_b32 s4, s7, 3
  s_lshl_b32 s5, s8, 15
  s_lshl_b32 s6, s4, 11
  s_add_u32 s6, s6, s5
  v_add_u32 v12, s6, v3
  s_cmp_eq_u32 s4, 0
  s_cbranch_scc1 L_g2o_20
  ds_write_b128 v12, v[64:67] offset:0
  ds_write_b128 v12, v[68:71] offset:1024
  s_branch L_g2e_21
L_g2o_20:
  v_mov_b32 v40, v64
  v_mov_b32 v41, v65
  v_mov_b32 v42, v66
  v_mov_b32 v43, v67
  v_mov_b32 v44, v68
  v_mov_b32 v45, v69
  v_mov_b32 v46, v70
  v_mov_b32 v47, v71
L_g2e_21:
  s_cmp_eq_u32 s4, 1
  s_cbranch_scc1 L_g2o_22
  ds_write_b128 v12, v[72:75] offset:8192
  ds_write_b128 v12, v[76:79] offset:9216
  s_branch L_g2e_23
L_g2o_22:
  v_mov_b32 v40, v72
  v_mov_b32 v41, v73
  v_mov_b32 v42, v74
  v_mov_b32 v43, v75
  v_mov_b32 v44, v76
  v_mov_b32 v45, v77
  v_mov_b32 v46, v78
  v_mov_b32 v47, v79
L_g2e_23:
  s_cmp_eq_u32 s4, 2
  s_cbranch_scc1 L_g2o_24
  ds_write_b128 v12, v[80:83] offset:16384
  ds_write_b128 v12, v[84:87] offset:17408
  s_branch L_g2e_25
L_g2o_24:
  v_mov_b32 v40, v80
  v_mov_b32 v41, v81
  v_mov_b32 v42, v82
  v_mov_b32 v43, v83
  v_mov_b32 v44, v84
  v_mov_b32 v45, v85
  v_mov_b32 v46, v86
  v_mov_b32 v47, v87
L_g2e_25:
  s_cmp_eq_u32 s4, 3
  s_cbranch_scc1 L_g2o_26
  ds_write_b128 v12, v[88:91] offset:24576
  ds_write_b128 v12, v[92:95] offset:25600
  s_branch L_g2e_27
L_g2o_26:
  v_mov_b32 v40, v88
  v_mov_b32 v41, v89
  v_mov_b32 v42, v90
  v_mov_b32 v43, v91
  v_mov_b32 v44, v92
  v_mov_b32 v45, v93
  v_mov_b32 v46, v94
  v_mov_b32 v47, v95
L_g2e_27:
  s_lshl_b32 s6, s4, 13
  s_add_u32 s6, s6, s5
  v_add_u32 v12, s6, v3
  s_waitcnt lgkmcnt(0)
  s_barrier
  s_add_u32 s6, s4, 1
  s_and_b32 s6, s6, 3
  s_lshl_b32 s6, s6, 11
  v_add_u32 v13, s6, v12
  ds_read_b128 v[96:99], v13 offset:0
  ds_read_b128 v[100:103], v13 offset:1024
  s_add_u32 s6, s4, 2
  s_and_b32 s6, s6, 3
  s_lshl_b32 s6, s6, 11
  v_add_u32 v14, s6, v12
  ds_read_b128 v[104:107], v14 offset:0
  ds_read_b128 v[108:111], v14 offset:1024
  s_add_u32 s6, s4, 3
  s_and_b32 s6, s6, 3
  s_lshl_b32 s6, s6, 11
  v_add_u32 v15, s6, v12
  ds_read_b128 v[112:115], v15 offset:0
  ds_read_b128 v[116:119], v15 offset:1024
  s_waitcnt lgkmcnt(2)
  v_add_f32 v96, v96, v104
  v_add_f32 v97, v97, v105
  v_add_f32 v98, v98, v106
  v_add_f32 v99, v99, v107
  v_add_f32 v100, v100, v108
  v_add_f32 v101, v101, v109
  v_add_f32 v102, v102, v110
  v_add_f32 v103, v103, v111
  s_waitcnt lgkmcnt(0)
  v_add_f32 v112, v112, v40
  v_add_f32 v113, v113, v41
  v_add_f32 v114, v114, v42
  v_add_f32 v115, v115, v43
  v_add_f32 v116, v116, v44
  v_add_f32 v117, v117, v45
  v_add_f32 v118, v118, v46
  v_add_f32 v119, v119, v47
  v_add_f32 v96, v96, v112
  v_add_f32 v97, v97, v113
  v_add_f32 v98, v98, v114
  v_add_f32 v99, v99, v115
  v_add_f32 v100, v100, v116
  v_add_f32 v101, v101, v117
  v_add_f32 v102, v102, v118
  v_add_f32 v103, v103, v119
  s_waitcnt vmcnt(0)
  v_cvt_pk_bf16_f32 v24, v96, v97
  v_lshlrev_b32 v25, 16, v24
  v_and_b32 v26, 0xffff0000, v24
  v_lshlrev_b32 v27, 16, v8
  v_and_b32 v28, 0xffff0000, v8
  v_lshlrev_b32 v16, 16, v16
  v_lshlrev_b32 v17, 16, v17
  v_add_f32 v27, v27, v16
  v_add_f32 v28, v28, v17
  v_cvt_pk_bf16_f32 v24, v27, v28
  v_lshlrev_b32 v27, 16, v24
  v_and_b32 v28, 0xffff0000, v24
  v_add_f32 v25, v25, v27
  v_add_f32 v26, v26, v28
  v_cvt_pk_bf16_f32 v32, v25, v26
  v_cvt_pk_bf16_f32 v24, v98, v99
  v_lshlrev_b32 v25, 16, v24
  v_and_b32 v26, 0xffff0000, v24
  v_lshlrev_b32 v27, 16, v9
  v_and_b32 v28, 0xffff0000, v9
  v_lshlrev_b32 v18, 16, v18
  v_lshlrev_b32 v19, 16, v19
  v_add_f32 v27, v27, v18
  v_add_f32 v28, v28, v19
  v_cvt_pk_bf16_f32 v24, v27, v28
  v_lshlrev_b32 v27, 16, v24
  v_and_b32 v28, 0xffff0000, v24
  v_add_f32 v25, v25, v27
  v_add_f32 v26, v26, v28
  v_cvt_pk_bf16_f32 v33, v25, v26
  buffer_store_dwordx2 v[32:33], v6, s[64:67], s10 offen offset:0
  v_cvt_pk_bf16_f32 v24, v100, v101
  v_lshlrev_b32 v25, 16, v24
  v_and_b32 v26, 0xffff0000, v24
  v_lshlrev_b32 v27, 16, v10
  v_and_b32 v28, 0xffff0000, v10
  v_lshlrev_b32 v20, 16, v20
  v_lshlrev_b32 v21, 16, v21
  v_add_f32 v27, v27, v20
  v_add_f32 v28, v28, v21
  v_cvt_pk_bf16_f32 v24, v27, v28
  v_lshlrev_b32 v27, 16, v24
  v_and_b32 v28, 0xffff0000, v24
  v_add_f32 v25, v25, v27
  v_add_f32 v26, v26, v28
  v_cvt_pk_bf16_f32 v34, v25, v26
  v_cvt_pk_bf16_f32 v24, v102, v103
  v_lshlrev_b32 v25, 16, v24
  v_and_b32 v26, 0xffff0000, v24
  v_lshlrev_b32 v27, 16, v11
  v_and_b32 v28, 0xffff0000, v11
  v_lshlrev_b32 v22, 16, v22
  v_lshlrev_b32 v23, 16, v23
  v_add_f32 v27, v27, v22
  v_add_f32 v28, v28, v23
  v_cvt_pk_bf16_f32 v24, v27, v28
  v_lshlrev_b32 v27, 16, v24
  v_and_b32 v28, 0xffff0000, v24
  v_add_f32 v25, v25, v27
  v_add_f32 v26, v26, v28
  v_cvt_pk_bf16_f32 v35, v25, v26
  buffer_store_dwordx2 v[34:35], v6, s[64:67], s10 offen offset:16
  s_or_b32 s4, s3, s7
  s_cmp_eq_u32 s4, 0
  s_cbranch_scc0 L_g2ep_28
  s_mov_b32 s9, 8192
  v_and_b32 v4, 63, v0
  v_lshlrev_b32 v4, 9, v4
  s_mov_b64 s[86:87], exec
  s_mov_b32 exec_lo, 0xffffffff
  s_mov_b32 exec_hi, 0xffffff
  s_mov_b32 s77, 0
L_wf_29:
  buffer_load_dword v8, v4, s[80:83], s9 offen offset:0 sc1
  buffer_load_dword v9, v4, s[80:83], s9 offen offset:128 sc1
  buffer_load_dword v10, v4, s[80:83], s9 offen offset:256 sc1
  buffer_load_dword v11, v4, s[80:83], s9 offen offset:384 sc1
  s_waitcnt vmcnt(0)
  v_cmp_ne_u32 vcc, s46, v8
  v_cmp_ne_u32 s[88:89], s46, v9
  s_nop 0
  s_or_b64 vcc, vcc, s[88:89]
  v_cmp_ne_u32 s[88:89], s46, v10
  s_nop 0
  s_or_b64 vcc, vcc, s[88:89]
  v_cmp_ne_u32 s[88:89], s46, v11
  s_nop 0
  s_or_b64 vcc, vcc, s[88:89]
  s_cbranch_vccz L_wfok_30
  s_add_u32 s77, s77, 1
  s_cmp_ge_u32 s77, 0x80000
  s_cbranch_scc1 L_wfok_30
  s_sleep 8
  s_branch L_wf_29
L_wfok_30:
  s_mov_b64 exec, s[86:87]
  v_mov_b32 v4, 0
  v_mov_b32 v5, s46
  s_mov_b64 s[86:87], exec
  s_mov_b64 exec, 1
  buffer_store_dword v5, v4, s[80:83], 0 offen offset:0 sc1
  s_mov_b64 exec, s[86:87]
L_g2ep_28:
L_end:
  s_endpgm
L_B:
  s_waitcnt lgkmcnt(0)
  s_add_u32 s80, s44, 0x1400000
  s_addc_u32 s81, s45, 0
  s_mov_b32 s82, 0x20000
  s_mov_b32 s83, 0x00020000
  s_load_dword s46, s[80:81], 0
  s_mov_b32 s3, s2
  s_setprio 2
  s_mov_b32 s48, s18
  s_mov_b32 s49, s19
  s_mov_b32 s50, 0x38000
  s_mov_b32 s51, 0x00020000
  s_mov_b32 s52, s20
  s_mov_b32 s53, s21
  s_mov_b32 s54, 0x38000
  s_mov_b32 s55, 0x00020000
  s_mov_b32 s56, s22
  s_mov_b32 s57, s23
  s_mov_b32 s58, 0x38000
  s_mov_b32 s59, 0x00020000
  s_mov_b32 s60, s24
  s_mov_b32 s61, s25
  s_mov_b32 s62, 0x38000
  s_mov_b32 s63, 0x00020000
  s_mov_b32 s64, s26
  s_mov_b32 s65, s27
  s_mov_b32 s66, 0x38000
  s_mov_b32 s67, 0x00020000
  s_mov_b32 s68, s28
  s_mov_b32 s69, s29
  s_mov_b32 s70, 0x38000
  s_mov_b32 s71, 0x00020000
  s_lshl_b32 s4, s3, 10
  v_lshlrev_b32 v3, 1, v0
  buffer_load_ushort v8, v3, s[48:51], s4 offen
  buffer_load_ushort v9, v3, s[52:55], s4 offen
  buffer_load_ushort v10, v3, s[56:59], s4 offen
  buffer_load_ushort v11, v3, s[60:63], s4 offen
  buffer_load_ushort v12, v3, s[64:67], s4 offen
  buffer_load_ushort v13, v3, s[68:71], s4 offen
  s_lshl_b32 s5, s3, 2
  s_load_dword s8, s[30:31], s5
  s_load_dword s9, s[32:33], s5
  v_lshrrev_b32 v4, 6, v0
  v_and_b32 v2, 63, v0
  v_mul_u32_u24 v6, 8704, v4
  v_lshl_add_u32 v7, v2, 2, v6
  v_and_b32 v3, 31, v2
  v_mul_u32_u24 v3, 272, v3
  v_add_u32 v6, v6, v3
  v_lshrrev_b32 v3, 5, v2
  v_lshl_add_u32 v6, v3, 4, v6
  v_readfirstlane_b32 s7, v4
  v_mov_b32 v48, 0
  v_mov_b32 v49, 0
  v_mov_b32 v50, 0
  v_mov_b32 v51, 0
  v_mov_b32 v52, 0
  v_mov_b32 v53, 0
  v_mov_b32 v54, 0
  v_mov_b32 v55, 0
  v_mov_b32 v56, 0
  v_mov_b32 v57, 0
  v_mov_b32 v58, 0
  v_mov_b32 v59, 0
  v_mov_b32 v60, 0
  v_mov_b32 v61, 0
  v_mov_b32 v62, 0
  v_mov_b32 v63, 0
  s_waitcnt lgkmcnt(0)
  s_add_u32 s46, s46, 1
  s_mov_b32 s47, s9
  v_lshrrev_b32 v4, 8, v0
  v_mov_b32 v5, s8
  v_lshlrev_b32 v3, 16, v5
  v_and_b32 v5, 0xffff0000, v5
  v_cmp_eq_u32 vcc, 0, v4
  s_nop 1
  v_cndmask_b32 v5, v5, v3, vcc
  v_mul_f32 v5, 0x3fb8aa3b, v5
  v_exp_f32 v5, v5
  s_nop 0
  v_cvt_pk_bf16_f32 v5, v5, v5
  v_lshlrev_b32 v5, 16, v5
  s_waitcnt vmcnt(0)
  s_mov_b32 s72, s38
  s_mov_b32 s73, s39
  s_mov_b32 s74, 0x188000
  s_mov_b32 s75, 0x00020000
  v_lshrrev_b32 v116, 5, v0
  v_and_b32 v117, 31, v0
  s_lshr_b32 s4, s3, 1
  s_mul_i32 s4, s4, 14336
  s_and_b32 s5, s3, 1
  s_mul_i32 s5, s5, 448
  s_add_u32 s4, s4, s5
  v_mul_u32_u24 v116, 896, v116
  v_lshl_add_u32 v116, v117, 4, v116
  buffer_load_dwordx4 v[124:127], v116, s[72:75], s4 offen
  v_lshlrev_b32 v8, 16, v8
  v_lshlrev_b32 v9, 16, v9
  v_lshlrev_b32 v10, 16, v10
  v_lshlrev_b32 v11, 16, v11
  v_lshlrev_b32 v12, 16, v12
  v_lshlrev_b32 v13, 16, v13
  v_mul_f32 v14, v5, v8
  v_mul_f32 v15, v5, v9
  v_mul_f32 v14, 0x3fb8aa3b, v14
  v_mul_f32 v15, 0.15915494, v15
  v_mul_f32 v10, v5, v10
  v_mul_f32 v11, v5, v11
  v_mul_f32 v86, 0x41000000, v14
  v_mul_f32 v88, 0x41800000, v14
  v_mul_f32 v90, 0x3f800000, v14
  v_mul_f32 v92, 0x43800000, v14
  v_mul_f32 v64, v13, v11
  v_mul_f32 v87, 0x41000000, v15
  v_mul_f32 v89, 0x41800000, v15
  v_mul_f32 v91, 0x3f800000, v15
  v_mul_f32 v93, 0x43800000, v15
  v_mul_f32 v65, v13, v10
  v_exp_f32 v86, v86
  v_exp_f32 v88, v88
  v_exp_f32 v90, v90
  v_exp_f32 v92, v92
  v_fma_f32 v64, v12, v10, -v64
  v_fract_f32 v87, v87
  v_fract_f32 v89, v89
  v_fract_f32 v91, v91
  v_fract_f32 v93, v93
  v_fma_f32 v65, v12, v11, v65
  v_cos_f32 v68, v87
  v_cos_f32 v76, v89
  v_cos_f32 v66, v91
  v_cos_f32 v70, v93
  v_sin_f32 v69, v87
  v_sin_f32 v77, v89
  v_sin_f32 v67, v91
  v_sin_f32 v71, v93
  v_mul_f32 v68, v68, v86
  v_mul_f32 v76, v76, v88
  v_mul_f32 v66, v66, v90
  v_mul_f32 v70, v70, v92
  v_mul_f32 v69, v69, v86
  v_mul_f32 v77, v77, v88
  v_mul_f32 v67, v67, v90
  v_mul_f32 v71, v71, v92
  v_mov_b32 v116, 0x3f80
  v_cvt_pk_bf16_f32 v114, v68, v69
  v_mul_f32 v72, v71, v71
  ds_write_b32 v7, v116 offset:0
  ds_write_b32 v7, v114 offset:272
  v_mul_f32 v73, v71, v70
  v_cvt_pk_bf16_f32 v112, v76, v77
  v_mul_f32 v82, v69, v77
  v_fma_f32 v72, v70, v70, -v72
  ds_write_b32 v7, v112 offset:544
  v_mul_f32 v83, v69, v76
  v_fma_f32 v73, v70, v71, v73
  v_mul_f32 v78, v77, v77
  v_fma_f32 v82, v68, v76, -v82
  v_mul_f32 v86, v65, v69
  v_mul_f32 v79, v77, v76
  v_fma_f32 v83, v68, v77, v83
  v_mul_f32 v87, v65, v68
  v_fma_f32 v78, v76, v76, -v78
  v_cvt_pk_bf16_f32 v115, v82, v83
  v_fma_f32 v86, v64, v68, -v86
  v_fma_f32 v79, v76, v77, v79
  ds_write_b32 v7, v115 offset:816
  v_fma_f32 v87, v64, v69, v87
  v_cvt_pk_bf16_f32 v113, v78, v79
  v_mul_f32 v84, v83, v77
  v_mul_f32 v74, v73, v73
  ds_write_b32 v7, v113 offset:1088
  v_mul_f32 v85, v83, v76
  v_mul_f32 v75, v73, v72
  v_mul_f32 v80, v79, v77
  v_fma_f32 v84, v82, v76, -v84
  v_fma_f32 v74, v72, v72, -v74
  v_mul_f32 v81, v79, v76
  v_fma_f32 v85, v82, v77, v85
  v_fma_f32 v75, v72, v73, v75
  v_fma_f32 v80, v78, v76, -v80
  v_cvt_pk_bf16_f32 v114, v84, v85
  v_mul_f32 v88, v65, v71
  v_fma_f32 v81, v78, v77, v81
  ds_write_b32 v7, v114 offset:1360
  v_mul_f32 v89, v65, v70
  v_cvt_pk_bf16_f32 v112, v80, v81
  v_mul_f32 v82, v85, v77
  v_fma_f32 v88, v64, v70, -v88
  ds_write_b32 v7, v112 offset:1632
  v_mul_f32 v83, v85, v76
  v_fma_f32 v89, v64, v71, v89
  v_mul_f32 v78, v81, v77
  v_fma_f32 v82, v84, v76, -v82
  v_mul_f32 v90, v87, v71
  v_mul_f32 v79, v81, v76
  v_fma_f32 v83, v84, v77, v83
  v_mul_f32 v91, v87, v70
  v_fma_f32 v78, v80, v76, -v78
  v_cvt_pk_bf16_f32 v115, v82, v83
  v_fma_f32 v90, v86, v70, -v90
  v_fma_f32 v79, v80, v77, v79
  ds_write_b32 v7, v115 offset:1904
  v_fma_f32 v91, v86, v71, v91
  v_cvt_pk_bf16_f32 v113, v78, v79
  v_mul_f32 v84, v83, v77
  v_mul_f32 v92, v65, v73
  ds_write_b32 v7, v113 offset:2176
  v_mul_f32 v85, v83, v76
  v_mul_f32 v93, v65, v72
  v_mul_f32 v80, v79, v77
  v_fma_f32 v84, v82, v76, -v84
  v_fma_f32 v92, v64, v72, -v92
  v_mul_f32 v81, v79, v76
  v_fma_f32 v85, v82, v77, v85
  v_fma_f32 v93, v64, v73, v93
  v_fma_f32 v80, v78, v76, -v80
  v_cvt_pk_bf16_f32 v114, v84, v85
  v_mul_f32 v94, v87, v73
  v_fma_f32 v81, v78, v77, v81
  ds_write_b32 v7, v114 offset:2448
  v_mul_f32 v95, v87, v72
  v_cvt_pk_bf16_f32 v112, v80, v81
  v_mul_f32 v82, v85, v77
  v_fma_f32 v94, v86, v72, -v94
  ds_write_b32 v7, v112 offset:2720
  v_mul_f32 v83, v85, v76
  v_fma_f32 v95, v86, v73, v95
  v_mul_f32 v78, v81, v77
  v_fma_f32 v82, v84, v76, -v82
  v_mul_f32 v79, v81, v76
  v_fma_f32 v83, v84, v77, v83
  v_fma_f32 v78, v80, v76, -v78
  v_cvt_pk_bf16_f32 v115, v82, v83
  v_fma_f32 v79, v80, v77, v79
  ds_write_b32 v7, v115 offset:2992
  v_cvt_pk_bf16_f32 v113, v78, v79
  v_mul_f32 v84, v83, v77
  ds_write_b32 v7, v113 offset:3264
  v_mul_f32 v85, v83, v76
  v_mul_f32 v80, v79, v77
  v_fma_f32 v84, v82, v76, -v84
  v_mul_f32 v81, v79, v76
  v_fma_f32 v85, v82, v77, v85
  v_fma_f32 v80, v78, v76, -v80
  v_cvt_pk_bf16_f32 v114, v84, v85
  v_fma_f32 v81, v78, v77, v81
  ds_write_b32 v7, v114 offset:3536
  v_cvt_pk_bf16_f32 v112, v80, v81
  v_mul_f32 v82, v85, v77
  ds_write_b32 v7, v112 offset:3808
  v_mul_f32 v83, v85, v76
  v_mul_f32 v78, v81, v77
  v_fma_f32 v82, v84, v76, -v82
  v_mul_f32 v79, v81, v76
  v_fma_f32 v83, v84, v77, v83
  v_fma_f32 v78, v80, v76, -v78
  v_cvt_pk_bf16_f32 v115, v82, v83
  v_fma_f32 v79, v80, v77, v79
  ds_write_b32 v7, v115 offset:4080
  v_cvt_pk_bf16_f32 v113, v78, v79
  v_mul_f32 v84, v83, v77
  ds_write_b32 v7, v113 offset:4352
  v_mul_f32 v85, v83, v76
  v_mul_f32 v80, v79, v77
  v_fma_f32 v84, v82, v76, -v84
  v_mul_f32 v81, v79, v76
  v_fma_f32 v85, v82, v77, v85
  v_fma_f32 v80, v78, v76, -v80
  v_cvt_pk_bf16_f32 v114, v84, v85
  v_fma_f32 v81, v78, v77, v81
  ds_write_b32 v7, v114 offset:4624
  v_cvt_pk_bf16_f32 v112, v80, v81
  v_mul_f32 v82, v85, v77
  ds_write_b32 v7, v112 offset:4896
  v_mul_f32 v83, v85, v76
  v_mul_f32 v78, v81, v77
  v_fma_f32 v82, v84, v76, -v82
  v_mul_f32 v79, v81, v76
  v_fma_f32 v83, v84, v77, v83
  v_fma_f32 v78, v80, v76, -v78
  v_cvt_pk_bf16_f32 v115, v82, v83
  v_fma_f32 v79, v80, v77, v79
  ds_write_b32 v7, v115 offset:5168
  v_cvt_pk_bf16_f32 v113, v78, v79
  v_mul_f32 v84, v83, v77
  ds_write_b32 v7, v113 offset:5440
  v_mul_f32 v85, v83, v76
  v_mul_f32 v80, v79, v77
  v_fma_f32 v84, v82, v76, -v84
  v_mul_f32 v81, v79, v76
  v_fma_f32 v85, v82, v77, v85
  v_fma_f32 v80, v78, v76, -v80
  v_cvt_pk_bf16_f32 v114, v84, v85
  v_fma_f32 v81, v78, v77, v81
  ds_write_b32 v7, v114 offset:5712
  v_cvt_pk_bf16_f32 v112, v80, v81
  v_mul_f32 v82, v85, v77
  ds_write_b32 v7, v112 offset:5984
  v_mul_f32 v83, v85, v76
  v_mul_f32 v78, v81, v77
  v_fma_f32 v82, v84, v76, -v82
  v_mul_f32 v79, v81, v76
  v_fma_f32 v83, v84, v77, v83
  v_fma_f32 v78, v80, v76, -v78
  v_cvt_pk_bf16_f32 v115, v82, v83
  v_fma_f32 v79, v80, v77, v79
  ds_write_b32 v7, v115 offset:6256
  v_cvt_pk_bf16_f32 v113, v78, v79
  v_mul_f32 v84, v83, v77
  ds_write_b32 v7, v113 offset:6528
  v_mul_f32 v85, v83, v76
  v_mul_f32 v80, v79, v77
  v_fma_f32 v84, v82, v76, -v84
  v_mul_f32 v81, v79, v76
  v_fma_f32 v85, v82, v77, v85
  v_fma_f32 v80, v78, v76, -v80
  v_cvt_pk_bf16_f32 v114, v84, v85
  v_fma_f32 v81, v78, v77, v81
  ds_write_b32 v7, v114 offset:6800
  v_cvt_pk_bf16_f32 v112, v80, v81
  v_mul_f32 v82, v85, v77
  ds_write_b32 v7, v112 offset:7072
  v_mul_f32 v83, v85, v76
  v_mul_f32 v78, v81, v77
  v_fma_f32 v82, v84, v76, -v82
  v_mul_f32 v79, v81, v76
  v_fma_f32 v83, v84, v77, v83
  v_fma_f32 v78, v80, v76, -v78
  v_cvt_pk_bf16_f32 v115, v82, v83
  v_fma_f32 v79, v80, v77, v79
  ds_write_b32 v7, v115 offset:7344
  v_cvt_pk_bf16_f32 v113, v78, v79
  v_mul_f32 v84, v83, v77
  ds_write_b32 v7, v113 offset:7616
  v_mul_f32 v85, v83, v76
  v_mul_f32 v80, v79, v77
  v_fma_f32 v84, v82, v76, -v84
  v_mul_f32 v81, v79, v76
  v_fma_f32 v85, v82, v77, v85
  v_fma_f32 v80, v78, v76, -v80
  v_cvt_pk_bf16_f32 v114, v84, v85
  v_fma_f32 v81, v78, v77, v81
  ds_write_b32 v7, v114 offset:7888
  v_cvt_pk_bf16_f32 v112, v80, v81
  v_mul_f32 v82, v85, v77
  ds_write_b32 v7, v112 offset:8160
  v_mul_f32 v83, v85, v76
  v_fma_f32 v82, v84, v76, -v82
  v_fma_f32 v83, v84, v77, v83
  v_cvt_pk_bf16_f32 v115, v82, v83
  ds_write_b32 v7, v115 offset:8432
  s_waitcnt lgkmcnt(0)
  ds_read_b128 v[16:19], v6 offset:0
  ds_read_b128 v[20:23], v6 offset:32
  ds_read_b128 v[24:27], v6 offset:64
  ds_read_b128 v[28:31], v6 offset:96
  ds_read_b128 v[32:35], v6 offset:128
  ds_read_b128 v[36:39], v6 offset:160
  ds_read_b128 v[40:43], v6 offset:192
  ds_read_b128 v[44:47], v6 offset:224
  s_waitcnt lgkmcnt(0)
  v_cvt_pk_bf16_f32 v108, v64, -v65
  v_cvt_pk_bf16_f32 v110, v88, -v89
  ds_write_b32 v7, v108 offset:0
  ds_write_b32 v7, v110 offset:4352
  v_mul_f32 v76, v65, v67
  v_cvt_pk_bf16_f32 v111, v90, -v91
  v_mul_f32 v77, v65, v66
  ds_write_b32 v7, v111 offset:6528
  v_fma_f32 v76, v64, v66, -v76
  v_cvt_pk_bf16_f32 v110, v92, -v93
  v_fma_f32 v77, v64, v67, v77
  ds_write_b32 v7, v110 offset:1088
  v_cvt_pk_bf16_f32 v109, v76, -v77
  v_cvt_pk_bf16_f32 v111, v94, -v95
  ds_write_b32 v7, v109 offset:272
  ds_write_b32 v7, v111 offset:1632
  v_mul_f32 v96, v77, v67
  v_mul_f32 v100, v89, v73
  v_mul_f32 v97, v77, v66
  v_mul_f32 v101, v89, v72
  v_fma_f32 v96, v76, v66, -v96
  v_fma_f32 v100, v88, v72, -v100
  v_fma_f32 v97, v76, v67, v97
  v_fma_f32 v101, v88, v73, v101
  v_cvt_pk_bf16_f32 v108, v96, -v97
  v_cvt_pk_bf16_f32 v110, v100, -v101
  ds_write_b32 v7, v108 offset:544
  ds_write_b32 v7, v110 offset:1904
  v_mul_f32 v76, v97, v67
  v_mul_f32 v102, v91, v73
  v_mul_f32 v77, v97, v66
  v_mul_f32 v103, v91, v72
  v_fma_f32 v76, v96, v66, -v76
  v_fma_f32 v102, v90, v72, -v102
  v_fma_f32 v77, v96, v67, v77
  v_fma_f32 v103, v90, v73, v103
  v_cvt_pk_bf16_f32 v109, v76, -v77
  v_cvt_pk_bf16_f32 v111, v102, -v103
  ds_write_b32 v7, v109 offset:816
  ds_write_b32 v7, v111 offset:3536
  v_mul_f32 v98, v77, v67
  v_mul_f32 v78, v65, v75
  v_mul_f32 v99, v77, v66
  v_mul_f32 v79, v65, v74
  v_fma_f32 v98, v76, v66, -v98
  v_fma_f32 v78, v64, v74, -v78
  v_fma_f32 v99, v76, v67, v99
  v_fma_f32 v79, v64, v75, v79
  v_cvt_pk_bf16_f32 v108, v98, -v99
  v_cvt_pk_bf16_f32 v110, v78, -v79
  ds_write_b32 v7, v108 offset:2176
  ds_write_b32 v7, v110 offset:3808
  v_mul_f32 v76, v99, v67
  v_mul_f32 v80, v87, v75
  v_mul_f32 v77, v99, v66
  v_mul_f32 v81, v87, v74
  v_fma_f32 v76, v98, v66, -v76
  v_fma_f32 v80, v86, v74, -v80
  v_fma_f32 v77, v98, v67, v77
  v_fma_f32 v81, v86, v75, v81
  v_cvt_pk_bf16_f32 v109, v76, -v77
  v_cvt_pk_bf16_f32 v111, v80, -v81
  ds_write_b32 v7, v109 offset:2448
  ds_write_b32 v7, v111 offset:4080
  v_mul_f32 v104, v77, v67
  v_mul_f32 v78, v89, v75
  v_mul_f32 v105, v77, v66
  v_mul_f32 v79, v89, v74
  v_fma_f32 v104, v76, v66, -v104
  v_fma_f32 v78, v88, v74, -v78
  v_fma_f32 v105, v76, v67, v105
  v_fma_f32 v79, v88, v75, v79
  v_cvt_pk_bf16_f32 v108, v104, -v105
  v_cvt_pk_bf16_f32 v110, v78, -v79
  ds_write_b32 v7, v108 offset:2720
  ds_write_b32 v7, v110 offset:5440
  v_mul_f32 v76, v105, v67
  v_mul_f32 v80, v91, v75
  v_mul_f32 v77, v105, v66
  v_mul_f32 v81, v91, v74
  v_fma_f32 v76, v104, v66, -v76
  v_fma_f32 v80, v90, v74, -v80
  v_fma_f32 v77, v104, v67, v77
  v_fma_f32 v81, v90, v75, v81
  v_cvt_pk_bf16_f32 v109, v76, -v77
  v_cvt_pk_bf16_f32 v111, v80, -v81
  ds_write_b32 v7, v109 offset:2992
  ds_write_b32 v7, v111 offset:5712
  v_mul_f32 v76, v97, v71
  v_mul_f32 v77, v97, v70
  v_fma_f32 v76, v96, v70, -v76
  v_fma_f32 v77, v96, v71, v77
  v_cvt_pk_bf16_f32 v108, v76, -v77
  ds_write_b32 v7, v108 offset:4624
  v_mul_f32 v76, v105, v71
  v_mul_f32 v77, v105, v70
  v_fma_f32 v76, v104, v70, -v76
  v_fma_f32 v77, v104, v71, v77
  v_cvt_pk_bf16_f32 v109, v76, -v77
  ds_write_b32 v7, v109 offset:5168
  v_mul_f32 v82, v93, v75
  v_mul_f32 v78, v99, v71
  v_mul_f32 v76, v99, v73
  v_mul_f32 v83, v93, v74
  v_mul_f32 v79, v99, v70
  v_mul_f32 v77, v99, v72
  v_fma_f32 v82, v92, v74, -v82
  v_fma_f32 v78, v98, v70, -v78
  v_fma_f32 v76, v98, v72, -v76
  v_fma_f32 v83, v92, v75, v83
  v_fma_f32 v79, v98, v71, v79
  v_fma_f32 v77, v98, v73, v77
  v_cvt_pk_bf16_f32 v113, v82, -v83
  v_cvt_pk_bf16_f32 v114, v78, -v79
  v_cvt_pk_bf16_f32 v108, v76, -v77
  ds_write_b32 v7, v113 offset:5984
  ds_write_b32 v7, v114 offset:4896
  ds_write_b32 v7, v108 offset:1360
  v_mul_f32 v84, v95, v75
  v_mul_f32 v80, v79, v73
  v_mul_f32 v85, v95, v74
  v_mul_f32 v81, v79, v72
  v_fma_f32 v84, v94, v74, -v84
  v_fma_f32 v80, v78, v72, -v80
  v_fma_f32 v85, v94, v75, v85
  v_fma_f32 v81, v78, v73, v81
  v_cvt_pk_bf16_f32 v112, v84, -v85
  v_cvt_pk_bf16_f32 v115, v80, -v81
  ds_write_b32 v7, v112 offset:6256
  ds_write_b32 v7, v115 offset:3264
  v_mul_f32 v82, v101, v75
  v_mul_f32 v83, v101, v74
  v_fma_f32 v82, v100, v74, -v82
  v_fma_f32 v83, v100, v75, v83
  v_cvt_pk_bf16_f32 v113, v82, -v83
  ds_write_b32 v7, v113 offset:7616
  v_mul_f32 v84, v103, v75
  v_mul_f32 v85, v103, v74
  v_fma_f32 v84, v102, v74, -v84
  v_fma_f32 v85, v102, v75, v85
  v_cvt_pk_bf16_f32 v112, v84, -v85
  ds_write_b32 v7, v112 offset:7888
  s_waitcnt lgkmcnt(0)
  ds_read_b128 v[64:67], v6 offset:0
  ds_read_b128 v[68:71], v6 offset:32
  ds_read_b128 v[72:75], v6 offset:64
  ds_read_b128 v[76:79], v6 offset:96
  ds_read_b128 v[80:83], v6 offset:128
  ds_read_b128 v[84:87], v6 offset:160
  ds_read_b128 v[88:91], v6 offset:192
  ds_read_b128 v[92:95], v6 offset:224
  s_waitcnt lgkmcnt(7)
  v_mfma_f32_32x32x16_bf16 v[48:63], v[64:67], v[16:19], v[48:63]
  s_waitcnt lgkmcnt(6)
  v_mfma_f32_32x32x16_bf16 v[48:63], v[68:71], v[20:23], v[48:63]
  s_waitcnt lgkmcnt(5)
  v_mfma_f32_32x32x16_bf16 v[48:63], v[72:75], v[24:27], v[48:63]
  s_waitcnt lgkmcnt(4)
  v_mfma_f32_32x32x16_bf16 v[48:63], v[76:79], v[28:31], v[48:63]
  s_waitcnt lgkmcnt(3)
  v_mfma_f32_32x32x16_bf16 v[48:63], v[80:83], v[32:35], v[48:63]
  s_waitcnt lgkmcnt(2)
  v_mfma_f32_32x32x16_bf16 v[48:63], v[84:87], v[36:39], v[48:63]
  s_waitcnt lgkmcnt(1)
  v_mfma_f32_32x32x16_bf16 v[48:63], v[88:91], v[40:43], v[48:63]
  s_waitcnt lgkmcnt(0)
  v_mfma_f32_32x32x16_bf16 v[48:63], v[92:95], v[44:47], v[48:63]
  s_waitcnt vmcnt(0)
  v_lshrrev_b32 v3, 5, v0
  v_and_b32 v4, 31, v0
  v_mul_u32_u24 v3, 528, v3
  v_lshl_add_u32 v3, v4, 4, v3
  v_add_u32 v3, 69632, v3
  ds_write_b128 v3, v[124:127]
  s_waitcnt lgkmcnt(0)
  s_barrier
  s_add_u32 s72, s44, 0x700000
  s_addc_u32 s73, s45, 0
  s_mov_b32 s74, 0x188000
  s_mov_b32 s75, 0x00020000
  v_lshrrev_b32 v4, 5, v2
  v_bfe_u32 v3, v2, 2, 2
  v_lshl_add_u32 v4, v4, 2, v3
  v_mul_u32_u24 v4, 528, v4
  v_bfe_u32 v3, v2, 4, 1
  v_lshl_add_u32 v4, v3, 5, v4
  v_and_b32 v3, 3, v2
  v_lshl_add_u32 v4, v3, 3, v4
  s_lshl_b32 s5, s7, 6
  s_add_u32 s5, s5, 69632
  v_add_u32 v4, s5, v4
  s_cmp_eq_u32 s7, 7
  s_cbranch_scc1 L_kgw2_31
  ds_read_b64_tr_b16 v[124:125], v4
  ds_read_b64_tr_b16 v[126:127], v4 offset:4224
  s_and_b32 s5, s3, 1
  s_mul_i32 s5, s5, 7
  s_add_u32 s5, s5, s7
  s_mul_i32 s5, s5, 112
  s_lshr_b32 s6, s3, 1
  s_add_u32 s5, s5, s6
  s_lshl_b32 s5, s5, 10
  v_lshlrev_b32 v3, 4, v2
  s_waitcnt lgkmcnt(0)
  buffer_store_dwordx4 v[124:127], v3, s[72:75], s5 offen sc1
L_kgw2_31:
  s_and_b32 s9, s7, 3
  s_lshr_b32 s10, s7, 2
  s_mul_i32 s11, s10, 33856
  v_lshlrev_b32 v4, 4, v2
  v_add_u32 v4, s11, v4
  s_cmp_eq_u32 s9, 0
  s_cbranch_scc1 L_kg_nw_32
  s_sub_u32 s5, s9, 1
  s_lshl_b32 s5, s5, 12
  v_add_u32 v5, s5, v4
  ds_write_b128 v5, v[48:51] offset:0
  ds_write_b128 v5, v[52:55] offset:1024
  ds_write_b128 v5, v[56:59] offset:2048
  ds_write_b128 v5, v[60:63] offset:3072
L_kg_nw_32:
  s_waitcnt vmcnt(0) lgkmcnt(0)
  s_barrier
  s_cmp_eq_u32 s7, 0
  s_cbranch_scc0 L_kgpub_35
  s_lshl_b32 s6, s3, 2
  s_add_u32 s6, s6, 36864
  v_mov_b32 v116, 0
  v_mov_b32 v117, s46
  s_mov_b64 s[86:87], exec
  s_mov_b64 exec, 1
  buffer_store_dword v117, v116, s[80:83], s6 offen sc1
  s_mov_b64 exec, s[86:87]
L_kgpub_35:
  s_setprio 0
  s_cmp_eq_u32 s9, 0
  s_cbranch_scc0 L_kg_end_34
  ds_read_b128 v[64:67], v4 offset:0
  ds_read_b128 v[68:71], v4 offset:1024
  ds_read_b128 v[72:75], v4 offset:2048
  ds_read_b128 v[76:79], v4 offset:3072
  ds_read_b128 v[80:83], v4 offset:4096
  ds_read_b128 v[84:87], v4 offset:5120
  ds_read_b128 v[88:91], v4 offset:6144
  ds_read_b128 v[92:95], v4 offset:7168
  ds_read_b128 v[96:99], v4 offset:8192
  ds_read_b128 v[100:103], v4 offset:9216
  ds_read_b128 v[104:107], v4 offset:10240
  ds_read_b128 v[108:111], v4 offset:11264
  s_waitcnt lgkmcnt(8)
  v_add_f32 v48, v48, v64
  v_add_f32 v49, v49, v65
  v_add_f32 v50, v50, v66
  v_add_f32 v51, v51, v67
  v_add_f32 v52, v52, v68
  v_add_f32 v53, v53, v69
  v_add_f32 v54, v54, v70
  v_add_f32 v55, v55, v71
  v_add_f32 v56, v56, v72
  v_add_f32 v57, v57, v73
  v_add_f32 v58, v58, v74
  v_add_f32 v59, v59, v75
  v_add_f32 v60, v60, v76
  v_add_f32 v61, v61, v77
  v_add_f32 v62, v62, v78
  v_add_f32 v63, v63, v79
  s_waitcnt lgkmcnt(4)
  v_add_f32 v48, v48, v80
  v_add_f32 v49, v49, v81
  v_add_f32 v50, v50, v82
  v_add_f32 v51, v51, v83
  v_add_f32 v52, v52, v84
  v_add_f32 v53, v53, v85
  v_add_f32 v54, v54, v86
  v_add_f32 v55, v55, v87
  v_add_f32 v56, v56, v88
  v_add_f32 v57, v57, v89
  v_add_f32 v58, v58, v90
  v_add_f32 v59, v59, v91
  v_add_f32 v60, v60, v92
  v_add_f32 v61, v61, v93
  v_add_f32 v62, v62, v94
  v_add_f32 v63, v63, v95
  s_waitcnt lgkmcnt(0)
  v_add_f32 v48, v48, v96
  v_add_f32 v49, v49, v97
  v_add_f32 v50, v50, v98
  v_add_f32 v51, v51, v99
  v_add_f32 v52, v52, v100
  v_add_f32 v53, v53, v101
  v_add_f32 v54, v54, v102
  v_add_f32 v55, v55, v103
  v_add_f32 v56, v56, v104
  v_add_f32 v57, v57, v105
  v_add_f32 v58, v58, v106
  v_add_f32 v59, v59, v107
  v_add_f32 v60, v60, v108
  v_add_f32 v61, v61, v109
  v_add_f32 v62, v62, v110
  v_add_f32 v63, v63, v111
  v_and_b32 v5, 31, v2
  v_lshlrev_b32 v5, 4, v5
  v_sub_u32 v6, 30000, v5
  v_add_u32 v6, s11, v6
  s_mov_b64 s[10:11], exec
  s_mov_b32 exec_lo, -1
  s_mov_b32 exec_hi, 0
  v_cvt_pk_bf16_f32 v64, v55, v54
  v_cvt_pk_bf16_f32 v65, v53, v52
  v_cvt_pk_bf16_f32 v66, v51, v50
  v_cvt_pk_bf16_f32 v67, v49, v48
  ds_write_b128 v6, v[64:67] offset:3584
  v_cvt_pk_bf16_f32 v68, v60, v59
  v_cvt_pk_bf16_f32 v69, v58, v58
  v_cvt_pk_bf16_f32 v70, v58, v57
  v_cvt_pk_bf16_f32 v71, v56, v56
  ds_write_b128 v6, v[68:71] offset:3072
  s_mov_b32 exec_lo, 0
  s_mov_b32 exec_hi, -1
  v_cvt_pk_bf16_f32 v72, v50, v50
  v_cvt_pk_bf16_f32 v73, v49, v49
  v_cvt_pk_bf16_f32 v74, v49, v48
  v_cvt_pk_bf16_f32 v75, v48, v48
  ds_write_b128 v6, v[72:75] offset:2560
  v_cvt_pk_bf16_f32 v76, v53, v53
  v_cvt_pk_bf16_f32 v77, v52, v52
  v_cvt_pk_bf16_f32 v78, v52, v51
  v_cvt_pk_bf16_f32 v79, v51, v51
  ds_write_b128 v6, v[76:79] offset:2048
  v_and_b32 v5, 1, v2
  v_cmp_eq_u32 vcc, 0, v5
  s_nop 1
  v_cndmask_b32 v104, v55, v54, vcc
  v_cvt_pk_bf16_f32 v80, v55, v55
  v_cvt_pk_bf16_f32 v81, v55, v104
  v_cvt_pk_bf16_f32 v82, v54, v54
  v_cvt_pk_bf16_f32 v83, v54, v54
  ds_write_b128 v6, v[80:83] offset:1536
  v_cndmask_b32 v104, v57, v56, vcc
  v_cvt_pk_bf16_f32 v84, v57, v57
  v_cvt_pk_bf16_f32 v85, v57, v104
  v_cvt_pk_bf16_f32 v86, v56, v56
  v_cvt_pk_bf16_f32 v87, v56, v56
  ds_write_b128 v6, v[84:87] offset:1024
  v_cndmask_b32 v104, v59, v58, vcc
  v_cvt_pk_bf16_f32 v88, v59, v59
  v_cvt_pk_bf16_f32 v89, v59, v104
  v_cvt_pk_bf16_f32 v90, v58, v58
  v_cvt_pk_bf16_f32 v91, v58, v58
  ds_write_b128 v6, v[88:91] offset:512
  v_cndmask_b32 v104, v61, v60, vcc
  v_cvt_pk_bf16_f32 v92, v61, v61
  v_cvt_pk_bf16_f32 v93, v61, v104
  v_cvt_pk_bf16_f32 v94, v60, v60
  v_cvt_pk_bf16_f32 v95, v60, v60
  ds_write_b128 v6, v[92:95] offset:0
  s_mov_b64 exec, s[10:11]
L_kg_end_34:
  s_waitcnt lgkmcnt(0)
  s_barrier
  s_add_u32 s48, s44, 0xd00000
  s_addc_u32 s49, s45, 0
  s_mov_b32 s50, 0x1c0000
  s_mov_b32 s51, 0x00020000
  s_add_u32 s56, s44, 0x1100000
  s_addc_u32 s57, s45, 0
  s_mov_b32 s58, 0x1c0000
  s_mov_b32 s59, 0x00020000
  v_lshrrev_b32 v12, 8, v0
  v_and_b32 v2, 255, v0
  v_mul_u32_u24 v5, 33856, v12
  v_mov_b32 v48, 0
  v_mov_b32 v49, 0
  v_mov_b32 v50, 0
  v_mov_b32 v51, 0
  v_lshl_add_u32 v6, v2, 4, v5
  v_cmp_gt_u32 vcc, 140, v2
  s_nop 0
  s_and_saveexec_b64 s[10:11], vcc
  ds_write_b128 v6, v[48:51] offset:7376
  ds_write_b128 v6, v[48:51] offset:14752
  ds_write_b128 v6, v[48:51] offset:22128
  ds_write_b128 v6, v[48:51] offset:0
  s_mov_b64 exec, s[10:11]
  v_cmp_gt_u32 vcc, 16, v2
  s_nop 0
  s_and_saveexec_b64 s[10:11], vcc
  ds_write_b128 v6, v[48:51] offset:33600
  s_mov_b64 exec, s[10:11]
  s_and_b32 s5, s2, 7
  s_lshl_b32 s5, s5, 12
  s_add_u32 s5, s5, 65536
  s_cmp_eq_u32 s7, 0
  s_cbranch_scc0 L_wgw_36
  v_and_b32 v3, 63, v0
  v_lshlrev_b32 v3, 2, v3
  s_mov_b64 s[86:87], exec
  s_mov_b32 exec_lo, 0xffffffff
  s_mov_b32 exec_hi, 0x0
  s_mov_b32 s77, 0
L_wf_37:
  buffer_load_dword v4, v3, s[80:83], s5 offen offset:0 sc1
  s_waitcnt vmcnt(0)
  v_cmp_ne_u32 vcc, s46, v4
  s_nop 4
  s_cbranch_vccz L_wfok_38
  s_add_u32 s77, s77, 1
  s_cmp_ge_u32 s77, 0x80000
  s_cbranch_scc1 L_wfok_38
  s_sleep 8
  s_branch L_wf_37
L_wfok_38:
  s_mov_b64 exec, s[86:87]
L_wgw_36:
  s_barrier
  s_lshl_b32 s4, s3, 7
  v_lshrrev_b32 v3, 2, v2
  v_mul_u32_u24 v3, 28672, v3
  v_lshl_add_u32 v3, v12, 6, v3
  v_and_b32 v4, 3, v2
  v_lshl_add_u32 v3, v4, 4, v3
  buffer_load_dwordx4 v[16:19], v3, s[48:51], s4 offen sc1
  v_cmp_eq_u32 vcc, 0, v4
  v_mov_b32 v4, 0xfffffff8
  v_mov_b32 v6, 0xffff9038
  v_cndmask_b32 v4, v4, v6, vcc
  v_add_u32 v4, v4, v3
  v_max_i32 v4, 0, v4
  buffer_load_dwordx2 v[20:21], v4, s[48:51], s4 offen sc1
  s_lshl_b32 s4, s3, 13
  v_lshrrev_b32 v7, 4, v2
  v_mul_u32_u24 v7, 320, v7
  v_and_b32 v8, 15, v2
  v_lshl_add_u32 v7, v8, 4, v7
  v_add_u32 v7, v7, v5
  v_cmp_eq_u32 vcc, 0, v2
  v_and_b32 v13, 63, v0
  v_bfe_u32 v14, v0, 6, 2
  v_lshrrev_b32 v3, 5, v13
  v_and_b32 v4, 3, v13
  v_add_u32 v4, 1, v4
  v_and_b32 v4, 3, v4
  v_bfe_u32 v6, v13, 2, 3
  v_mul_u32_u24 v8, 7376, v4
  v_mul_u32_u24 v9, 320, v6
  v_add3_u32 v8, v8, v9, v5
  v_lshl_add_u32 v8, v3, 4, v8
  v_mul_u32_u24 v9, 640, v14
  v_sub_u32 v8, v8, v9
  v_and_b32 v4, 31, v13
  v_lshlrev_b32 v9, 3, v4
  v_sub_u32 v9, v5, v9
  v_lshl_add_u32 v9, v3, 4, v9
  v_lshlrev_b32 v10, 9, v14
  v_sub_u32 v9, v9, v10
  v_add_u32 v9, 33336, v9
  v_add_u32 v10, -2048, v9
  v_mov_b32 v64, 0
  v_mov_b32 v65, 0
  v_mov_b32 v66, 0
  v_mov_b32 v67, 0
  v_mov_b32 v68, 0
  v_mov_b32 v69, 0
  v_mov_b32 v70, 0
  v_mov_b32 v71, 0
  v_mov_b32 v72, 0
  v_mov_b32 v73, 0
  v_mov_b32 v74, 0
  v_mov_b32 v75, 0
  v_mov_b32 v76, 0
  v_mov_b32 v77, 0
  v_mov_b32 v78, 0
  v_mov_b32 v79, 0
  v_mov_b32 v80, 0
  v_mov_b32 v81, 0
  v_mov_b32 v82, 0
  v_mov_b32 v83, 0
  v_mov_b32 v84, 0
  v_mov_b32 v85, 0
  v_mov_b32 v86, 0
  v_mov_b32 v87, 0
  v_mov_b32 v88, 0
  v_mov_b32 v89, 0
  v_mov_b32 v90, 0
  v_mov_b32 v91, 0
  v_mov_b32 v92, 0
  v_mov_b32 v93, 0
  v_mov_b32 v94, 0
  v_mov_b32 v95, 0
  s_waitcnt vmcnt(0)
  v_cndmask_b32_e64 v20, v20, 0, vcc
  v_cndmask_b32_e64 v21, v21, 0, vcc
  ds_write_b128 v7, v[16:19] offset:2240
  v_mov_b32 v52, v21
  v_mov_b32 v53, v16
  v_mov_b32 v54, v17
  v_mov_b32 v55, v18
  ds_write_b128 v7, v[52:55] offset:16992
  v_alignbit_b32 v56, v16, v21, 16
  v_alignbit_b32 v57, v17, v16, 16
  v_alignbit_b32 v58, v18, v17, 16
  v_alignbit_b32 v59, v19, v18, 16
  ds_write_b128 v7, v[56:59] offset:24368
  v_alignbit_b32 v60, v21, v20, 16
  v_mov_b32 v61, v56
  v_mov_b32 v62, v57
  v_mov_b32 v63, v58
  ds_write_b128 v7, v[60:63] offset:9616
  s_waitcnt lgkmcnt(0)
  s_barrier
  ds_read_b128 v[16:19], v8 offset:2464
  ds_read_b64 v[24:25], v9 offset:480
  ds_read_b64 v[26:27], v9 offset:488
  ds_read_b128 v[20:23], v8 offset:5024
  ds_read_b64 v[28:29], v10 offset:480
  ds_read_b64 v[30:31], v10 offset:488
  ds_read_b128 v[32:35], v8 offset:2432
  ds_read_b64 v[40:41], v9 offset:448
  ds_read_b64 v[42:43], v9 offset:456
  ds_read_b128 v[36:39], v8 offset:4992
  ds_read_b64 v[44:45], v10 offset:448
  ds_read_b64 v[46:47], v10 offset:456
  s_waitcnt lgkmcnt(6)
  v_mfma_f32_32x32x16_bf16 v[64:79], v[16:19], v[24:27], v[64:79]
  ds_read_b128 v[48:51], v8 offset:2400
  ds_read_b64 v[56:57], v9 offset:416
  v_mfma_f32_32x32x16_bf16 v[80:95], v[20:23], v[24:27], v[80:95]
  ds_read_b64 v[58:59], v9 offset:424
  ds_read_b128 v[52:55], v8 offset:4960
  v_mfma_f32_32x32x16_bf16 v[80:95], v[16:19], v[28:31], v[80:95]
  ds_read_b64 v[60:61], v10 offset:416
  ds_read_b64 v[62:63], v10 offset:424
  s_waitcnt lgkmcnt(6)
  v_mfma_f32_32x32x16_bf16 v[64:79], v[32:35], v[40:43], v[64:79]
  ds_read_b128 v[16:19], v8 offset:2368
  ds_read_b64 v[24:25], v9 offset:384
  v_mfma_f32_32x32x16_bf16 v[80:95], v[36:39], v[40:43], v[80:95]
  ds_read_b64 v[26:27], v9 offset:392
  ds_read_b128 v[20:23], v8 offset:4928
  v_mfma_f32_32x32x16_bf16 v[80:95], v[32:35], v[44:47], v[80:95]
  ds_read_b64 v[28:29], v10 offset:384
  ds_read_b64 v[30:31], v10 offset:392
  s_waitcnt lgkmcnt(6)
  v_mfma_f32_32x32x16_bf16 v[64:79], v[48:51], v[56:59], v[64:79]
  ds_read_b128 v[32:35], v8 offset:2336
  ds_read_b64 v[40:41], v9 offset:352
  v_mfma_f32_32x32x16_bf16 v[80:95], v[52:55], v[56:59], v[80:95]
  ds_read_b64 v[42:43], v9 offset:360
  ds_read_b128 v[36:39], v8 offset:4896
  v_mfma_f32_32x32x16_bf16 v[80:95], v[48:51], v[60:63], v[80:95]
  ds_read_b64 v[44:45], v10 offset:352
  ds_read_b64 v[46:47], v10 offset:360
  s_waitcnt lgkmcnt(6)
  v_mfma_f32_32x32x16_bf16 v[64:79], v[16:19], v[24:27], v[64:79]
  ds_read_b128 v[48:51], v8 offset:2304
  ds_read_b64 v[56:57], v9 offset:320
  v_mfma_f32_32x32x16_bf16 v[80:95], v[20:23], v[24:27], v[80:95]
  ds_read_b64 v[58:59], v9 offset:328
  ds_read_b128 v[52:55], v8 offset:4864
  v_mfma_f32_32x32x16_bf16 v[80:95], v[16:19], v[28:31], v[80:95]
  ds_read_b64 v[60:61], v10 offset:320
  ds_read_b64 v[62:63], v10 offset:328
  s_waitcnt lgkmcnt(6)
  v_mfma_f32_32x32x16_bf16 v[64:79], v[32:35], v[40:43], v[64:79]
  ds_read_b128 v[16:19], v8 offset:2272
  ds_read_b64 v[24:25], v9 offset:288
  v_mfma_f32_32x32x16_bf16 v[80:95], v[36:39], v[40:43], v[80:95]
  ds_read_b64 v[26:27], v9 offset:296
  ds_read_b128 v[20:23], v8 offset:4832
  v_mfma_f32_32x32x16_bf16 v[80:95], v[32:35], v[44:47], v[80:95]
  ds_read_b64 v[28:29], v10 offset:288
  ds_read_b64 v[30:31], v10 offset:296
  s_waitcnt lgkmcnt(6)
  v_mfma_f32_32x32x16_bf16 v[64:79], v[48:51], v[56:59], v[64:79]
  ds_read_b128 v[32:35], v8 offset:2240
  ds_read_b64 v[40:41], v9 offset:256
  v_mfma_f32_32x32x16_bf16 v[80:95], v[52:55], v[56:59], v[80:95]
  ds_read_b64 v[42:43], v9 offset:264
  ds_read_b128 v[36:39], v8 offset:4800
  v_mfma_f32_32x32x16_bf16 v[80:95], v[48:51], v[60:63], v[80:95]
  ds_read_b64 v[44:45], v10 offset:256
  ds_read_b64 v[46:47], v10 offset:264
  s_waitcnt lgkmcnt(6)
  v_mfma_f32_32x32x16_bf16 v[64:79], v[16:19], v[24:27], v[64:79]
  ds_read_b128 v[48:51], v8 offset:2144
  ds_read_b64 v[56:57], v9 offset:224
  v_mfma_f32_32x32x16_bf16 v[80:95], v[20:23], v[24:27], v[80:95]
  ds_read_b64 v[58:59], v9 offset:232
  ds_read_b128 v[52:55], v8 offset:4704
  v_mfma_f32_32x32x16_bf16 v[80:95], v[16:19], v[28:31], v[80:95]
  ds_read_b64 v[60:61], v10 offset:224
  ds_read_b64 v[62:63], v10 offset:232
  s_waitcnt lgkmcnt(6)
  v_mfma_f32_32x32x16_bf16 v[64:79], v[32:35], v[40:43], v[64:79]
  ds_read_b128 v[16:19], v8 offset:2112
  ds_read_b64 v[24:25], v9 offset:192
  v_mfma_f32_32x32x16_bf16 v[80:95], v[36:39], v[40:43], v[80:95]
  ds_read_b64 v[26:27], v9 offset:200
  ds_read_b128 v[20:23], v8 offset:4672
  v_mfma_f32_32x32x16_bf16 v[80:95], v[32:35], v[44:47], v[80:95]
  ds_read_b64 v[28:29], v10 offset:192
  ds_read_b64 v[30:31], v10 offset:200
  s_waitcnt lgkmcnt(6)
  v_mfma_f32_32x32x16_bf16 v[64:79], v[48:51], v[56:59], v[64:79]
  ds_read_b128 v[32:35], v8 offset:2080
  ds_read_b64 v[40:41], v9 offset:160
  v_mfma_f32_32x32x16_bf16 v[80:95], v[52:55], v[56:59], v[80:95]
  ds_read_b64 v[42:43], v9 offset:168
  ds_read_b128 v[36:39], v8 offset:4640
  v_mfma_f32_32x32x16_bf16 v[80:95], v[48:51], v[60:63], v[80:95]
  ds_read_b64 v[44:45], v10 offset:160
  ds_read_b64 v[46:47], v10 offset:168
  s_waitcnt lgkmcnt(6)
  v_mfma_f32_32x32x16_bf16 v[64:79], v[16:19], v[24:27], v[64:79]
  ds_read_b128 v[48:51], v8 offset:2048
  ds_read_b64 v[56:57], v9 offset:128
  v_mfma_f32_32x32x16_bf16 v[80:95], v[20:23], v[24:27], v[80:95]
  ds_read_b64 v[58:59], v9 offset:136
  ds_read_b128 v[52:55], v8 offset:4608
  v_mfma_f32_32x32x16_bf16 v[80:95], v[16:19], v[28:31], v[80:95]
  ds_read_b64 v[60:61], v10 offset:128
  ds_read_b64 v[62:63], v10 offset:136
  s_waitcnt lgkmcnt(6)
  v_mfma_f32_32x32x16_bf16 v[64:79], v[32:35], v[40:43], v[64:79]
  ds_read_b128 v[16:19], v8 offset:2016
  ds_read_b64 v[24:25], v9 offset:96
  v_mfma_f32_32x32x16_bf16 v[80:95], v[36:39], v[40:43], v[80:95]
  ds_read_b64 v[26:27], v9 offset:104
  ds_read_b128 v[20:23], v8 offset:4576
  v_mfma_f32_32x32x16_bf16 v[80:95], v[32:35], v[44:47], v[80:95]
  ds_read_b64 v[28:29], v10 offset:96
  ds_read_b64 v[30:31], v10 offset:104
  s_waitcnt lgkmcnt(6)
  v_mfma_f32_32x32x16_bf16 v[64:79], v[48:51], v[56:59], v[64:79]
  ds_read_b128 v[32:35], v8 offset:1984
  ds_read_b64 v[40:41], v9 offset:64
  v_mfma_f32_32x32x16_bf16 v[80:95], v[52:55], v[56:59], v[80:95]
  ds_read_b64 v[42:43], v9 offset:72
  ds_read_b128 v[36:39], v8 offset:4544
  v_mfma_f32_32x32x16_bf16 v[80:95], v[48:51], v[60:63], v[80:95]
  ds_read_b64 v[44:45], v10 offset:64
  ds_read_b64 v[46:47], v10 offset:72
  s_waitcnt lgkmcnt(6)
  v_mfma_f32_32x32x16_bf16 v[64:79], v[16:19], v[24:27], v[64:79]
  ds_read_b128 v[48:51], v8 offset:1952
  ds_read_b64 v[56:57], v9 offset:32
  v_mfma_f32_32x32x16_bf16 v[80:95], v[20:23], v[24:27], v[80:95]
  ds_read_b64 v[58:59], v9 offset:40
  ds_read_b128 v[52:55], v8 offset:4512
  v_mfma_f32_32x32x16_bf16 v[80:95], v[16:19], v[28:31], v[80:95]
  ds_read_b64 v[60:61], v10 offset:32
  ds_read_b64 v[62:63], v10 offset:40
  s_waitcnt lgkmcnt(6)
  v_mfma_f32_32x32x16_bf16 v[64:79], v[32:35], v[40:43], v[64:79]
  ds_read_b128 v[16:19], v8 offset:1920
  ds_read_b64 v[24:25], v9 offset:0
  v_mfma_f32_32x32x16_bf16 v[80:95], v[36:39], v[40:43], v[80:95]
  ds_read_b64 v[26:27], v9 offset:8
  ds_read_b128 v[20:23], v8 offset:4480
  v_mfma_f32_32x32x16_bf16 v[80:95], v[32:35], v[44:47], v[80:95]
  ds_read_b64 v[28:29], v10 offset:0
  ds_read_b64 v[30:31], v10 offset:8
  s_waitcnt lgkmcnt(6)
  v_mfma_f32_32x32x16_bf16 v[64:79], v[48:51], v[56:59], v[64:79]
  v_mfma_f32_32x32x16_bf16 v[80:95], v[52:55], v[56:59], v[80:95]
  v_mfma_f32_32x32x16_bf16 v[80:95], v[48:51], v[60:63], v[80:95]
  s_waitcnt lgkmcnt(0)
  v_mfma_f32_32x32x16_bf16 v[64:79], v[16:19], v[24:27], v[64:79]
  v_mfma_f32_32x32x16_bf16 v[80:95], v[20:23], v[24:27], v[80:95]
  v_mfma_f32_32x32x16_bf16 v[80:95], v[16:19], v[28:31], v[80:95]
  v_lshlrev_b32 v3, 4, v13
  v_add_u32 v3, v3, v5
  s_and_b32 s9, s7, 3
  s_barrier
  s_cmp_eq_u32 s9, 0
  s_cbranch_scc1 L_cvo_39
  s_cmp_gt_u32 s9, 0
  s_cselect_b32 s5, 1, 0
  s_sub_u32 s5, s9, s5
  s_lshl_b32 s5, s5, 11
  v_add_u32 v4, s5, v3
  ds_write_b128 v4, v[64:67] offset:7376
  ds_write_b128 v4, v[68:71] offset:8400
  s_branch L_cve_40
L_cvo_39:
  s_nop 3
  v_mov_b32 v40, v64
  v_mov_b32 v41, v65
  v_mov_b32 v42, v66
  v_mov_b32 v43, v67
  v_mov_b32 v44, v68
  v_mov_b32 v45, v69
  v_mov_b32 v46, v70
  v_mov_b32 v47, v71
L_cve_40:
  s_cmp_eq_u32 s9, 1
  s_cbranch_scc1 L_cvo_41
  s_cmp_gt_u32 s9, 1
  s_cselect_b32 s5, 1, 0
  s_sub_u32 s5, s9, s5
  s_lshl_b32 s5, s5, 11
  v_add_u32 v4, s5, v3
  ds_write_b128 v4, v[72:75] offset:13520
  ds_write_b128 v4, v[76:79] offset:14544
  s_branch L_cve_42
L_cvo_41:
  v_mov_b32 v40, v72
  v_mov_b32 v41, v73
  v_mov_b32 v42, v74
  v_mov_b32 v43, v75
  v_mov_b32 v44, v76
  v_mov_b32 v45, v77
  v_mov_b32 v46, v78
  v_mov_b32 v47, v79
L_cve_42:
  s_cmp_eq_u32 s9, 2
  s_cbranch_scc1 L_cvo_43
  s_cmp_gt_u32 s9, 2
  s_cselect_b32 s5, 1, 0
  s_sub_u32 s5, s9, s5
  s_lshl_b32 s5, s5, 11
  v_add_u32 v4, s5, v3
  ds_write_b128 v4, v[80:83] offset:19664
  ds_write_b128 v4, v[84:87] offset:20688
  s_branch L_cve_44
L_cvo_43:
  v_mov_b32 v40, v80
  v_mov_b32 v41, v81
  v_mov_b32 v42, v82
  v_mov_b32 v43, v83
  v_mov_b32 v44, v84
  v_mov_b32 v45, v85
  v_mov_b32 v46, v86
  v_mov_b32 v47, v87
L_cve_44:
  s_cmp_eq_u32 s9, 3
  s_cbranch_scc1 L_cvo_45
  s_cmp_gt_u32 s9, 3
  s_cselect_b32 s5, 1, 0
  s_sub_u32 s5, s9, s5
  s_lshl_b32 s5, s5, 11
  v_add_u32 v4, s5, v3
  ds_write_b128 v4, v[88:91] offset:25808
  ds_write_b128 v4, v[92:95] offset:26832
  s_branch L_cve_46
L_cvo_45:
  v_mov_b32 v40, v88
  v_mov_b32 v41, v89
  v_mov_b32 v42, v90
  v_mov_b32 v43, v91
  v_mov_b32 v44, v92
  v_mov_b32 v45, v93
  v_mov_b32 v46, v94
  v_mov_b32 v47, v95
L_cve_46:
  s_mul_i32 s5, s9, 6144
  v_add_u32 v4, s5, v3
  v_lshrrev_b32 v3, 5, v13
  v_lshrrev_b32 v6, 1, v14
  v_and_b32 v7, 1, v14
  v_lshl_add_u32 v6, v6, 3, v3
  v_lshl_add_u32 v6, v7, 2, v6
  v_mul_u32_u24 v7, 320, v6
  v_and_b32 v9, 31, v13
  v_lshl_add_u32 v7, v9, 3, v7
  v_add_u32 v7, v7, v5
  v_lshlrev_b32 v8, 12, v12
  v_lshl_add_u32 v8, v6, 8, v8
  v_lshl_add_u32 v8, v9, 3, v8
  v_mov_b32 v10, s47
  v_lshlrev_b32 v11, 16, v10
  v_and_b32 v10, 0xffff0000, v10
  v_cmp_eq_u32 vcc, 0, v12
  s_nop 1
  v_cndmask_b32 v10, v10, v11, vcc
  s_waitcnt lgkmcnt(0)
  s_barrier
  ds_read_b128 v[16:19], v4 offset:7376
  ds_read_b128 v[20:23], v4 offset:8400
  ds_read_b128 v[24:27], v4 offset:9424
  ds_read_b128 v[28:31], v4 offset:10448
  ds_read_b128 v[32:35], v4 offset:11472
  ds_read_b128 v[36:39], v4 offset:12496
  ds_read_b64 v[48:49], v7 offset:2240
  ds_read_b64 v[50:51], v7 offset:2880
  s_waitcnt lgkmcnt(4)
  v_add_f32 v16, v16, v24
  v_add_f32 v17, v17, v25
  v_add_f32 v18, v18, v26
  v_add_f32 v19, v19, v27
  v_add_f32 v20, v20, v28
  v_add_f32 v21, v21, v29
  v_add_f32 v22, v22, v30
  v_add_f32 v23, v23, v31
  s_waitcnt lgkmcnt(2)
  v_add_f32 v32, v32, v40
  v_add_f32 v33, v33, v41
  v_add_f32 v34, v34, v42
  v_add_f32 v35, v35, v43
  v_add_f32 v36, v36, v44
  v_add_f32 v37, v37, v45
  v_add_f32 v38, v38, v46
  v_add_f32 v39, v39, v47
  v_add_f32 v16, v16, v32
  v_add_f32 v17, v17, v33
  v_add_f32 v18, v18, v34
  v_add_f32 v19, v19, v35
  v_add_f32 v20, v20, v36
  v_add_f32 v21, v21, v37
  v_add_f32 v22, v22, v38
  v_add_f32 v23, v23, v39
  s_waitcnt lgkmcnt(0)
  v_cvt_pk_bf16_f32 v56, v16, v17
  v_lshlrev_b32 v57, 16, v56
  v_and_b32 v58, 0xffff0000, v56
  v_lshlrev_b32 v59, 16, v48
  v_and_b32 v60, 0xffff0000, v48
  v_mul_f32 v59, v59, v10
  v_mul_f32 v60, v60, v10
  v_cvt_pk_bf16_f32 v56, v59, v60
  v_lshlrev_b32 v59, 16, v56
  v_and_b32 v60, 0xffff0000, v56
  v_add_f32 v57, v57, v59
  v_add_f32 v58, v58, v60
  v_cvt_pk_bf16_f32 v64, v57, v58
  v_cvt_pk_bf16_f32 v56, v18, v19
  v_lshlrev_b32 v57, 16, v56
  v_and_b32 v58, 0xffff0000, v56
  v_lshlrev_b32 v59, 16, v49
  v_and_b32 v60, 0xffff0000, v49
  v_mul_f32 v59, v59, v10
  v_mul_f32 v60, v60, v10
  v_cvt_pk_bf16_f32 v56, v59, v60
  v_lshlrev_b32 v59, 16, v56
  v_and_b32 v60, 0xffff0000, v56
  v_add_f32 v57, v57, v59
  v_add_f32 v58, v58, v60
  v_cvt_pk_bf16_f32 v65, v57, v58
  buffer_store_dwordx2 v[64:65], v8, s[56:59], s4 offen offset:0 sc1
  v_cvt_pk_bf16_f32 v56, v20, v21
  v_lshlrev_b32 v57, 16, v56
  v_and_b32 v58, 0xffff0000, v56
  v_lshlrev_b32 v59, 16, v50
  v_and_b32 v60, 0xffff0000, v50
  v_mul_f32 v59, v59, v10
  v_mul_f32 v60, v60, v10
  v_cvt_pk_bf16_f32 v56, v59, v60
  v_lshlrev_b32 v59, 16, v56
  v_and_b32 v60, 0xffff0000, v56
  v_add_f32 v57, v57, v59
  v_add_f32 v58, v58, v60
  v_cvt_pk_bf16_f32 v66, v57, v58
  v_cvt_pk_bf16_f32 v56, v22, v23
  v_lshlrev_b32 v57, 16, v56
  v_and_b32 v58, 0xffff0000, v56
  v_lshlrev_b32 v59, 16, v51
  v_and_b32 v60, 0xffff0000, v51
  v_mul_f32 v59, v59, v10
  v_mul_f32 v60, v60, v10
  v_cvt_pk_bf16_f32 v56, v59, v60
  v_lshlrev_b32 v59, 16, v56
  v_and_b32 v60, 0xffff0000, v56
  v_add_f32 v57, v57, v59
  v_add_f32 v58, v58, v60
  v_cvt_pk_bf16_f32 v67, v57, v58
  buffer_store_dwordx2 v[66:67], v8, s[56:59], s4 offen offset:512 sc1
  s_waitcnt vmcnt(0)
  s_barrier
  s_cmp_eq_u32 s7, 0
  s_cbranch_scc0 L_cvpub_47
  s_lshl_b32 s6, s3, 2
  s_add_u32 s6, s6, 98304
  v_and_b32 v3, 7, v0
  v_mul_u32_u24 v3, 1024, v3
  v_mov_b32 v4, s46
  s_mov_b64 s[86:87], exec
  s_mov_b64 exec, 0xff
  buffer_store_dword v4, v3, s[80:83], s6 offen sc1
  s_mov_b64 exec, s[86:87]
L_cvpub_47:
  s_endpgm
L_LN:
  s_waitcnt lgkmcnt(0)
  s_add_u32 s80, s44, 0x1400000
  s_addc_u32 s81, s45, 0
  s_mov_b32 s82, 0x20000
  s_mov_b32 s83, 0x00020000
  s_load_dword s46, s[80:81], 0
  s_sub_u32 s3, s2, 224
  s_mov_b32 s48, s16
  s_mov_b32 s49, s17
  s_mov_b32 s50, 0x1c0000
  s_mov_b32 s51, 0x00020000
  s_add_u32 s56, s44, 0xd00000
  s_addc_u32 s57, s45, 0
  s_mov_b32 s58, 0x1c0000
  s_mov_b32 s59, 0x00020000
  s_add_u32 s60, s44, 0x1300000
  s_addc_u32 s61, s45, 0
  s_mov_b32 s62, 0x4000
  s_mov_b32 s63, 0x00020000
  v_lshrrev_b32 v104, 3, v0
  v_and_b32 v2, 7, v0
  s_mul_i32 s4, s3, 57344
  v_mul_u32_u24 v3, 896, v104
  v_lshl_add_u32 v3, v2, 4, v3
  buffer_load_dwordx4 v[8:11], v3, s[48:51], s4 offen offset:0
  buffer_load_dwordx4 v[12:15], v3, s[48:51], s4 offen offset:128
  buffer_load_dwordx4 v[16:19], v3, s[48:51], s4 offen offset:256
  buffer_load_dwordx4 v[20:23], v3, s[48:51], s4 offen offset:384
  buffer_load_dwordx4 v[24:27], v3, s[48:51], s4 offen offset:512
  buffer_load_dwordx4 v[28:31], v3, s[48:51], s4 offen offset:640
  buffer_load_dwordx4 v[32:35], v3, s[48:51], s4 offen offset:768
  s_getpc_b64 s[4:5]
L_pc:
  s_sub_u32 s4, s4, L_pc-parallel_sum__ssm_conv_s4__dense_activation_relu__prompt_kernel
  s_subb_u32 s5, s5, 0
  v_lshlrev_b32 v110, 7, v0
  v_cmp_gt_u32 vcc, L_code_end-parallel_sum__ssm_conv_s4__dense_activation_relu__prompt_kernel, v110
  s_nop 0
  s_and_saveexec_b64 s[10:11], vcc
  s_cbranch_execz L_cpf_48
  v_mov_b32 v113, s5
  v_add_co_u32 v112, vcc, s4, v110
  s_nop 1
  v_addc_co_u32 v113, vcc, 0, v113, vcc
  global_load_dword v111, v[112:113], off
L_cpf_48:
  s_mov_b64 exec, s[10:11]
  s_mul_i32 s4, s3, 57344
  v_mul_u32_u24 v5, 912, v104
  v_lshl_add_u32 v5, v2, 4, v5
  s_waitcnt lgkmcnt(0)
  s_add_u32 s46, s46, 1
  s_waitcnt vmcnt(6)
  v_lshlrev_b32 v40, 16, v8
  v_and_b32 v41, 0xffff0000, v8
  v_lshlrev_b32 v42, 16, v9
  v_and_b32 v43, 0xffff0000, v9
  v_lshlrev_b32 v44, 16, v10
  v_and_b32 v45, 0xffff0000, v10
  v_lshlrev_b32 v46, 16, v11
  v_and_b32 v47, 0xffff0000, v11
  s_waitcnt vmcnt(5)
  v_lshlrev_b32 v48, 16, v12
  v_and_b32 v49, 0xffff0000, v12
  v_lshlrev_b32 v50, 16, v13
  v_and_b32 v51, 0xffff0000, v13
  v_lshlrev_b32 v52, 16, v14
  v_and_b32 v53, 0xffff0000, v14
  v_lshlrev_b32 v54, 16, v15
  v_and_b32 v55, 0xffff0000, v15
  s_waitcnt vmcnt(4)
  v_lshlrev_b32 v56, 16, v16
  v_and_b32 v57, 0xffff0000, v16
  v_lshlrev_b32 v58, 16, v17
  v_and_b32 v59, 0xffff0000, v17
  v_lshlrev_b32 v60, 16, v18
  v_and_b32 v61, 0xffff0000, v18
  v_lshlrev_b32 v62, 16, v19
  v_and_b32 v63, 0xffff0000, v19
  s_waitcnt vmcnt(3)
  v_lshlrev_b32 v64, 16, v20
  v_and_b32 v65, 0xffff0000, v20
  v_lshlrev_b32 v66, 16, v21
  v_and_b32 v67, 0xffff0000, v21
  v_lshlrev_b32 v68, 16, v22
  v_and_b32 v69, 0xffff0000, v22
  v_lshlrev_b32 v70, 16, v23
  v_and_b32 v71, 0xffff0000, v23
  s_waitcnt vmcnt(2)
  v_lshlrev_b32 v72, 16, v24
  v_and_b32 v73, 0xffff0000, v24
  v_lshlrev_b32 v74, 16, v25
  v_and_b32 v75, 0xffff0000, v25
  v_lshlrev_b32 v76, 16, v26
  v_and_b32 v77, 0xffff0000, v26
  v_lshlrev_b32 v78, 16, v27
  v_and_b32 v79, 0xffff0000, v27
  s_waitcnt vmcnt(1)
  v_lshlrev_b32 v80, 16, v28
  v_and_b32 v81, 0xffff0000, v28
  v_lshlrev_b32 v82, 16, v29
  v_and_b32 v83, 0xffff0000, v29
  v_lshlrev_b32 v84, 16, v30
  v_and_b32 v85, 0xffff0000, v30
  v_lshlrev_b32 v86, 16, v31
  v_and_b32 v87, 0xffff0000, v31
  s_waitcnt vmcnt(0)
  v_lshlrev_b32 v88, 16, v32
  v_and_b32 v89, 0xffff0000, v32
  v_lshlrev_b32 v90, 16, v33
  v_and_b32 v91, 0xffff0000, v33
  v_lshlrev_b32 v92, 16, v34
  v_and_b32 v93, 0xffff0000, v34
  v_lshlrev_b32 v94, 16, v35
  v_and_b32 v95, 0xffff0000, v35
  v_add_f32 v6, v40, v42
  v_add_f32 v7, v41, v43
  v_add_f32 v96, v44, v46
  v_add_f32 v97, v45, v47
  v_add_f32 v6, v6, v48
  v_add_f32 v7, v7, v49
  v_add_f32 v96, v96, v50
  v_add_f32 v97, v97, v51
  v_add_f32 v6, v6, v52
  v_add_f32 v7, v7, v53
  v_add_f32 v96, v96, v54
  v_add_f32 v97, v97, v55
  v_add_f32 v6, v6, v56
  v_add_f32 v7, v7, v57
  v_add_f32 v96, v96, v58
  v_add_f32 v97, v97, v59
  v_add_f32 v6, v6, v60
  v_add_f32 v7, v7, v61
  v_add_f32 v96, v96, v62
  v_add_f32 v97, v97, v63
  v_add_f32 v6, v6, v64
  v_add_f32 v7, v7, v65
  v_add_f32 v96, v96, v66
  v_add_f32 v97, v97, v67
  v_add_f32 v6, v6, v68
  v_add_f32 v7, v7, v69
  v_add_f32 v96, v96, v70
  v_add_f32 v97, v97, v71
  v_add_f32 v6, v6, v72
  v_add_f32 v7, v7, v73
  v_add_f32 v96, v96, v74
  v_add_f32 v97, v97, v75
  v_add_f32 v6, v6, v76
  v_add_f32 v7, v7, v77
  v_add_f32 v96, v96, v78
  v_add_f32 v97, v97, v79
  v_add_f32 v6, v6, v80
  v_add_f32 v7, v7, v81
  v_add_f32 v96, v96, v82
  v_add_f32 v97, v97, v83
  v_add_f32 v6, v6, v84
  v_add_f32 v7, v7, v85
  v_add_f32 v96, v96, v86
  v_add_f32 v97, v97, v87
  v_add_f32 v6, v6, v88
  v_add_f32 v7, v7, v89
  v_add_f32 v96, v96, v90
  v_add_f32 v97, v97, v91
  v_add_f32 v6, v6, v92
  v_add_f32 v7, v7, v93
  v_add_f32 v96, v96, v94
  v_add_f32 v97, v97, v95
  v_add_f32 v6, v6, v7
  v_add_f32 v96, v96, v97
  v_add_f32 v6, v6, v96
  s_nop 1
  v_add_f32_dpp v6, v6, v6 quad_perm:[1,0,3,2] row_mask:0xf bank_mask:0xf
  s_nop 1
  v_add_f32_dpp v6, v6, v6 quad_perm:[2,3,0,1] row_mask:0xf bank_mask:0xf
  s_nop 1
  v_add_f32_dpp v6, v6, v6 row_half_mirror row_mask:0xf bank_mask:0xf
  s_mov_b32 s5, 0x3b124925
  v_mul_f32 v6, s5, v6
  v_cvt_pk_bf16_f32 v98, v6, v6
  v_lshlrev_b32 v98, 16, v98
  v_mov_b32 v7, v6
  v_mov_b32 v106, 0
  v_mov_b32 v107, 0
  v_mov_b32 v108, 0
  v_mov_b32 v109, 0
  v_sub_f32 v100, v40, v6
  v_sub_f32 v101, v41, v7
  v_fmac_f32 v106, v100, v100
  v_fmac_f32 v107, v101, v101
  v_sub_f32 v102, v42, v6
  v_sub_f32 v103, v43, v7
  v_fmac_f32 v108, v102, v102
  v_fmac_f32 v109, v103, v103
  v_sub_f32 v100, v44, v6
  v_sub_f32 v101, v45, v7
  v_fmac_f32 v106, v100, v100
  v_fmac_f32 v107, v101, v101
  v_sub_f32 v102, v46, v6
  v_sub_f32 v103, v47, v7
  v_fmac_f32 v108, v102, v102
  v_fmac_f32 v109, v103, v103
  v_sub_f32 v100, v48, v6
  v_sub_f32 v101, v49, v7
  v_fmac_f32 v106, v100, v100
  v_fmac_f32 v107, v101, v101
  v_sub_f32 v102, v50, v6
  v_sub_f32 v103, v51, v7
  v_fmac_f32 v108, v102, v102
  v_fmac_f32 v109, v103, v103
  v_sub_f32 v100, v52, v6
  v_sub_f32 v101, v53, v7
  v_fmac_f32 v106, v100, v100
  v_fmac_f32 v107, v101, v101
  v_sub_f32 v102, v54, v6
  v_sub_f32 v103, v55, v7
  v_fmac_f32 v108, v102, v102
  v_fmac_f32 v109, v103, v103
  v_sub_f32 v100, v56, v6
  v_sub_f32 v101, v57, v7
  v_fmac_f32 v106, v100, v100
  v_fmac_f32 v107, v101, v101
  v_sub_f32 v102, v58, v6
  v_sub_f32 v103, v59, v7
  v_fmac_f32 v108, v102, v102
  v_fmac_f32 v109, v103, v103
  v_sub_f32 v100, v60, v6
  v_sub_f32 v101, v61, v7
  v_fmac_f32 v106, v100, v100
  v_fmac_f32 v107, v101, v101
  v_sub_f32 v102, v62, v6
  v_sub_f32 v103, v63, v7
  v_fmac_f32 v108, v102, v102
  v_fmac_f32 v109, v103, v103
  v_sub_f32 v100, v64, v6
  v_sub_f32 v101, v65, v7
  v_fmac_f32 v106, v100, v100
  v_fmac_f32 v107, v101, v101
  v_sub_f32 v102, v66, v6
  v_sub_f32 v103, v67, v7
  v_fmac_f32 v108, v102, v102
  v_fmac_f32 v109, v103, v103
  v_sub_f32 v100, v68, v6
  v_sub_f32 v101, v69, v7
  v_fmac_f32 v106, v100, v100
  v_fmac_f32 v107, v101, v101
  v_sub_f32 v102, v70, v6
  v_sub_f32 v103, v71, v7
  v_fmac_f32 v108, v102, v102
  v_fmac_f32 v109, v103, v103
  v_sub_f32 v100, v72, v6
  v_sub_f32 v101, v73, v7
  v_fmac_f32 v106, v100, v100
  v_fmac_f32 v107, v101, v101
  v_sub_f32 v102, v74, v6
  v_sub_f32 v103, v75, v7
  v_fmac_f32 v108, v102, v102
  v_fmac_f32 v109, v103, v103
  v_sub_f32 v100, v76, v6
  v_sub_f32 v101, v77, v7
  v_fmac_f32 v106, v100, v100
  v_fmac_f32 v107, v101, v101
  v_sub_f32 v102, v78, v6
  v_sub_f32 v103, v79, v7
  v_fmac_f32 v108, v102, v102
  v_fmac_f32 v109, v103, v103
  v_sub_f32 v100, v80, v6
  v_sub_f32 v101, v81, v7
  v_fmac_f32 v106, v100, v100
  v_fmac_f32 v107, v101, v101
  v_sub_f32 v102, v82, v6
  v_sub_f32 v103, v83, v7
  v_fmac_f32 v108, v102, v102
  v_fmac_f32 v109, v103, v103
  v_sub_f32 v100, v84, v6
  v_sub_f32 v101, v85, v7
  v_fmac_f32 v106, v100, v100
  v_fmac_f32 v107, v101, v101
  v_sub_f32 v102, v86, v6
  v_sub_f32 v103, v87, v7
  v_fmac_f32 v108, v102, v102
  v_fmac_f32 v109, v103, v103
  v_sub_f32 v100, v88, v6
  v_sub_f32 v101, v89, v7
  v_fmac_f32 v106, v100, v100
  v_fmac_f32 v107, v101, v101
  v_sub_f32 v102, v90, v6
  v_sub_f32 v103, v91, v7
  v_fmac_f32 v108, v102, v102
  v_fmac_f32 v109, v103, v103
  v_sub_f32 v100, v92, v6
  v_sub_f32 v101, v93, v7
  v_fmac_f32 v106, v100, v100
  v_fmac_f32 v107, v101, v101
  v_sub_f32 v102, v94, v6
  v_sub_f32 v103, v95, v7
  v_fmac_f32 v108, v102, v102
  v_fmac_f32 v109, v103, v103
  v_add_f32 v106, v106, v107
  v_add_f32 v108, v108, v109
  v_add_f32 v7, v106, v108
  s_nop 1
  v_add_f32_dpp v7, v7, v7 quad_perm:[1,0,3,2] row_mask:0xf bank_mask:0xf
  s_nop 1
  v_add_f32_dpp v7, v7, v7 quad_perm:[2,3,0,1] row_mask:0xf bank_mask:0xf
  s_nop 1
  v_add_f32_dpp v7, v7, v7 row_half_mirror row_mask:0xf bank_mask:0xf
  v_mul_f32 v7, s5, v7
  v_cvt_pk_bf16_f32 v7, v7, v7
  v_lshlrev_b32 v7, 16, v7
  v_add_f32 v7, 0x3727c5ac, v7
  v_cvt_pk_bf16_f32 v7, v7, v7
  v_lshlrev_b32 v7, 16, v7
  v_sqrt_f32 v7, v7
  s_nop 0
  v_cvt_pk_bf16_f32 v99, v7, v7
  v_lshlrev_b32 v99, 16, v99
  v_rcp_f32 v99, v99
  s_lshl_b32 s6, s3, 9
  v_lshlrev_b32 v100, 3, v104
  buffer_store_dwordx2 v[98:99], v100, s[60:63], s6 offen sc1
  v_readfirstlane_b32 s7, v0
  v_sub_f32 v40, v40, v98
  v_sub_f32 v41, v41, v98
  v_cvt_pk_bf16_f32 v8, v40, v41
  v_sub_f32 v42, v42, v98
  v_sub_f32 v43, v43, v98
  v_cvt_pk_bf16_f32 v9, v42, v43
  v_sub_f32 v44, v44, v98
  v_sub_f32 v45, v45, v98
  v_cvt_pk_bf16_f32 v10, v44, v45
  v_sub_f32 v46, v46, v98
  v_sub_f32 v47, v47, v98
  v_cvt_pk_bf16_f32 v11, v46, v47
  v_lshlrev_b32 v40, 16, v8
  v_and_b32 v41, 0xffff0000, v8
  v_mul_f32 v40, v40, v99
  v_mul_f32 v41, v41, v99
  v_cvt_pk_bf16_f32 v8, v40, v41
  v_lshlrev_b32 v42, 16, v9
  v_and_b32 v43, 0xffff0000, v9
  v_mul_f32 v42, v42, v99
  v_mul_f32 v43, v43, v99
  v_cvt_pk_bf16_f32 v9, v42, v43
  v_lshlrev_b32 v44, 16, v10
  v_and_b32 v45, 0xffff0000, v10
  v_mul_f32 v44, v44, v99
  v_mul_f32 v45, v45, v99
  v_cvt_pk_bf16_f32 v10, v44, v45
  v_lshlrev_b32 v46, 16, v11
  v_and_b32 v47, 0xffff0000, v11
  v_mul_f32 v46, v46, v99
  v_mul_f32 v47, v47, v99
  v_cvt_pk_bf16_f32 v11, v46, v47
  ds_write_b128 v5, v[8:11] offset:0
  v_sub_f32 v48, v48, v98
  v_sub_f32 v49, v49, v98
  v_cvt_pk_bf16_f32 v12, v48, v49
  v_sub_f32 v50, v50, v98
  v_sub_f32 v51, v51, v98
  v_cvt_pk_bf16_f32 v13, v50, v51
  v_sub_f32 v52, v52, v98
  v_sub_f32 v53, v53, v98
  v_cvt_pk_bf16_f32 v14, v52, v53
  v_sub_f32 v54, v54, v98
  v_sub_f32 v55, v55, v98
  v_cvt_pk_bf16_f32 v15, v54, v55
  v_lshlrev_b32 v48, 16, v12
  v_and_b32 v49, 0xffff0000, v12
  v_mul_f32 v48, v48, v99
  v_mul_f32 v49, v49, v99
  v_cvt_pk_bf16_f32 v12, v48, v49
  v_lshlrev_b32 v50, 16, v13
  v_and_b32 v51, 0xffff0000, v13
  v_mul_f32 v50, v50, v99
  v_mul_f32 v51, v51, v99
  v_cvt_pk_bf16_f32 v13, v50, v51
  v_lshlrev_b32 v52, 16, v14
  v_and_b32 v53, 0xffff0000, v14
  v_mul_f32 v52, v52, v99
  v_mul_f32 v53, v53, v99
  v_cvt_pk_bf16_f32 v14, v52, v53
  v_lshlrev_b32 v54, 16, v15
  v_and_b32 v55, 0xffff0000, v15
  v_mul_f32 v54, v54, v99
  v_mul_f32 v55, v55, v99
  v_cvt_pk_bf16_f32 v15, v54, v55
  ds_write_b128 v5, v[12:15] offset:128
  v_sub_f32 v56, v56, v98
  v_sub_f32 v57, v57, v98
  v_cvt_pk_bf16_f32 v16, v56, v57
  v_sub_f32 v58, v58, v98
  v_sub_f32 v59, v59, v98
  v_cvt_pk_bf16_f32 v17, v58, v59
  v_sub_f32 v60, v60, v98
  v_sub_f32 v61, v61, v98
  v_cvt_pk_bf16_f32 v18, v60, v61
  v_sub_f32 v62, v62, v98
  v_sub_f32 v63, v63, v98
  v_cvt_pk_bf16_f32 v19, v62, v63
  v_lshlrev_b32 v56, 16, v16
  v_and_b32 v57, 0xffff0000, v16
  v_mul_f32 v56, v56, v99
  v_mul_f32 v57, v57, v99
  v_cvt_pk_bf16_f32 v16, v56, v57
  v_lshlrev_b32 v58, 16, v17
  v_and_b32 v59, 0xffff0000, v17
  v_mul_f32 v58, v58, v99
  v_mul_f32 v59, v59, v99
  v_cvt_pk_bf16_f32 v17, v58, v59
  v_lshlrev_b32 v60, 16, v18
  v_and_b32 v61, 0xffff0000, v18
  v_mul_f32 v60, v60, v99
  v_mul_f32 v61, v61, v99
  v_cvt_pk_bf16_f32 v18, v60, v61
  v_lshlrev_b32 v62, 16, v19
  v_and_b32 v63, 0xffff0000, v19
  v_mul_f32 v62, v62, v99
  v_mul_f32 v63, v63, v99
  v_cvt_pk_bf16_f32 v19, v62, v63
  ds_write_b128 v5, v[16:19] offset:256
  v_sub_f32 v64, v64, v98
  v_sub_f32 v65, v65, v98
  v_cvt_pk_bf16_f32 v20, v64, v65
  v_sub_f32 v66, v66, v98
  v_sub_f32 v67, v67, v98
  v_cvt_pk_bf16_f32 v21, v66, v67
  v_sub_f32 v68, v68, v98
  v_sub_f32 v69, v69, v98
  v_cvt_pk_bf16_f32 v22, v68, v69
  v_sub_f32 v70, v70, v98
  v_sub_f32 v71, v71, v98
  v_cvt_pk_bf16_f32 v23, v70, v71
  v_lshlrev_b32 v64, 16, v20
  v_and_b32 v65, 0xffff0000, v20
  v_mul_f32 v64, v64, v99
  v_mul_f32 v65, v65, v99
  v_cvt_pk_bf16_f32 v20, v64, v65
  v_lshlrev_b32 v66, 16, v21
  v_and_b32 v67, 0xffff0000, v21
  v_mul_f32 v66, v66, v99
  v_mul_f32 v67, v67, v99
  v_cvt_pk_bf16_f32 v21, v66, v67
  v_lshlrev_b32 v68, 16, v22
  v_and_b32 v69, 0xffff0000, v22
  v_mul_f32 v68, v68, v99
  v_mul_f32 v69, v69, v99
  v_cvt_pk_bf16_f32 v22, v68, v69
  v_lshlrev_b32 v70, 16, v23
  v_and_b32 v71, 0xffff0000, v23
  v_mul_f32 v70, v70, v99
  v_mul_f32 v71, v71, v99
  v_cvt_pk_bf16_f32 v23, v70, v71
  ds_write_b128 v5, v[20:23] offset:384
  v_sub_f32 v72, v72, v98
  v_sub_f32 v73, v73, v98
  v_cvt_pk_bf16_f32 v24, v72, v73
  v_sub_f32 v74, v74, v98
  v_sub_f32 v75, v75, v98
  v_cvt_pk_bf16_f32 v25, v74, v75
  v_sub_f32 v76, v76, v98
  v_sub_f32 v77, v77, v98
  v_cvt_pk_bf16_f32 v26, v76, v77
  v_sub_f32 v78, v78, v98
  v_sub_f32 v79, v79, v98
  v_cvt_pk_bf16_f32 v27, v78, v79
  v_lshlrev_b32 v72, 16, v24
  v_and_b32 v73, 0xffff0000, v24
  v_mul_f32 v72, v72, v99
  v_mul_f32 v73, v73, v99
  v_cvt_pk_bf16_f32 v24, v72, v73
  v_lshlrev_b32 v74, 16, v25
  v_and_b32 v75, 0xffff0000, v25
  v_mul_f32 v74, v74, v99
  v_mul_f32 v75, v75, v99
  v_cvt_pk_bf16_f32 v25, v74, v75
  v_lshlrev_b32 v76, 16, v26
  v_and_b32 v77, 0xffff0000, v26
  v_mul_f32 v76, v76, v99
  v_mul_f32 v77, v77, v99
  v_cvt_pk_bf16_f32 v26, v76, v77
  v_lshlrev_b32 v78, 16, v27
  v_and_b32 v79, 0xffff0000, v27
  v_mul_f32 v78, v78, v99
  v_mul_f32 v79, v79, v99
  v_cvt_pk_bf16_f32 v27, v78, v79
  ds_write_b128 v5, v[24:27] offset:512
  v_sub_f32 v80, v80, v98
  v_sub_f32 v81, v81, v98
  v_cvt_pk_bf16_f32 v28, v80, v81
  v_sub_f32 v82, v82, v98
  v_sub_f32 v83, v83, v98
  v_cvt_pk_bf16_f32 v29, v82, v83
  v_sub_f32 v84, v84, v98
  v_sub_f32 v85, v85, v98
  v_cvt_pk_bf16_f32 v30, v84, v85
  v_sub_f32 v86, v86, v98
  v_sub_f32 v87, v87, v98
  v_cvt_pk_bf16_f32 v31, v86, v87
  v_lshlrev_b32 v80, 16, v28
  v_and_b32 v81, 0xffff0000, v28
  v_mul_f32 v80, v80, v99
  v_mul_f32 v81, v81, v99
  v_cvt_pk_bf16_f32 v28, v80, v81
  v_lshlrev_b32 v82, 16, v29
  v_and_b32 v83, 0xffff0000, v29
  v_mul_f32 v82, v82, v99
  v_mul_f32 v83, v83, v99
  v_cvt_pk_bf16_f32 v29, v82, v83
  v_lshlrev_b32 v84, 16, v30
  v_and_b32 v85, 0xffff0000, v30
  v_mul_f32 v84, v84, v99
  v_mul_f32 v85, v85, v99
  v_cvt_pk_bf16_f32 v30, v84, v85
  v_lshlrev_b32 v86, 16, v31
  v_and_b32 v87, 0xffff0000, v31
  v_mul_f32 v86, v86, v99
  v_mul_f32 v87, v87, v99
  v_cvt_pk_bf16_f32 v31, v86, v87
  ds_write_b128 v5, v[28:31] offset:640
  v_sub_f32 v88, v88, v98
  v_sub_f32 v89, v89, v98
  v_cvt_pk_bf16_f32 v32, v88, v89
  v_sub_f32 v90, v90, v98
  v_sub_f32 v91, v91, v98
  v_cvt_pk_bf16_f32 v33, v90, v91
  v_sub_f32 v92, v92, v98
  v_sub_f32 v93, v93, v98
  v_cvt_pk_bf16_f32 v34, v92, v93
  v_sub_f32 v94, v94, v98
  v_sub_f32 v95, v95, v98
  v_cvt_pk_bf16_f32 v35, v94, v95
  v_lshlrev_b32 v88, 16, v32
  v_and_b32 v89, 0xffff0000, v32
  v_mul_f32 v88, v88, v99
  v_mul_f32 v89, v89, v99
  v_cvt_pk_bf16_f32 v32, v88, v89
  v_lshlrev_b32 v90, 16, v33
  v_and_b32 v91, 0xffff0000, v33
  v_mul_f32 v90, v90, v99
  v_mul_f32 v91, v91, v99
  v_cvt_pk_bf16_f32 v33, v90, v91
  v_lshlrev_b32 v92, 16, v34
  v_and_b32 v93, 0xffff0000, v34
  v_mul_f32 v92, v92, v99
  v_mul_f32 v93, v93, v99
  v_cvt_pk_bf16_f32 v34, v92, v93
  v_lshlrev_b32 v94, 16, v35
  v_and_b32 v95, 0xffff0000, v35
  v_mul_f32 v94, v94, v99
  v_mul_f32 v95, v95, v99
  v_cvt_pk_bf16_f32 v35, v94, v95
  ds_write_b128 v5, v[32:35] offset:768
  v_and_b32 v104, 63, v0
  v_lshrrev_b32 v2, 4, v104
  v_bfe_u32 v3, v104, 2, 2
  v_and_b32 v6, 3, v104
  v_bfe_u32 v8, v0, 6, 1
  v_lshl_add_u32 v7, v2, 3, v3
  v_lshl_add_u32 v7, v8, 5, v7
  v_mul_u32_u24 v7, 912, v7
  v_lshl_add_u32 v7, v6, 3, v7
  v_lshrrev_b32 v6, 7, v0
  v_lshl_add_u32 v7, v6, 5, v7
  v_and_b32 v3, 15, v104
  v_lshl_add_u32 v3, v6, 4, v3
  v_lshlrev_b32 v3, 6, v3
  v_lshl_add_u32 v3, v2, 4, v3
  v_mul_u32_u24 v8, 28672, v8
  v_add_u32 v3, v3, v8
  s_mul_i32 s6, s3, 57344
  s_waitcnt vmcnt(0) lgkmcnt(0)
  s_barrier
  s_cmp_lt_u32 s7, 64
  s_cbranch_scc0 L_lnpub_49
  s_lshl_b32 s5, s3, 7
  s_add_u32 s5, s5, 4096
  v_mov_b32 v100, 0
  v_mov_b32 v101, s46
  s_mov_b64 s[86:87], exec
  s_mov_b64 exec, 1
  buffer_store_dword v101, v100, s[80:83], s5 offen sc1
  s_mov_b64 exec, s[86:87]
L_lnpub_49:
  ds_read_b64_tr_b16 v[40:41], v7 offset:0
  ds_read_b64_tr_b16 v[42:43], v7 offset:3648
  ds_read_b64_tr_b16 v[44:45], v7 offset:128
  ds_read_b64_tr_b16 v[46:47], v7 offset:3776
  ds_read_b64_tr_b16 v[48:49], v7 offset:256
  ds_read_b64_tr_b16 v[50:51], v7 offset:3904
  ds_read_b64_tr_b16 v[52:53], v7 offset:384
  ds_read_b64_tr_b16 v[54:55], v7 offset:4032
  ds_read_b64_tr_b16 v[56:57], v7 offset:512
  ds_read_b64_tr_b16 v[58:59], v7 offset:4160
  ds_read_b64_tr_b16 v[60:61], v7 offset:640
  ds_read_b64_tr_b16 v[62:63], v7 offset:4288
  ds_read_b64_tr_b16 v[64:65], v7 offset:768
  ds_read_b64_tr_b16 v[66:67], v7 offset:4416
  s_waitcnt lgkmcnt(12)
  buffer_store_dwordx4 v[40:43], v3, s[56:59], s6 offen sc1
  v_add_u32 v3, 4096, v3
  s_waitcnt lgkmcnt(10)
  buffer_store_dwordx4 v[44:47], v3, s[56:59], s6 offen sc1
  v_add_u32 v3, 4096, v3
  s_waitcnt lgkmcnt(8)
  buffer_store_dwordx4 v[48:51], v3, s[56:59], s6 offen sc1
  v_add_u32 v3, 4096, v3
  s_waitcnt lgkmcnt(6)
  buffer_store_dwordx4 v[52:55], v3, s[56:59], s6 offen sc1
  v_add_u32 v3, 4096, v3
  s_waitcnt lgkmcnt(4)
  buffer_store_dwordx4 v[56:59], v3, s[56:59], s6 offen sc1
  v_add_u32 v3, 4096, v3
  s_waitcnt lgkmcnt(2)
  buffer_store_dwordx4 v[60:63], v3, s[56:59], s6 offen sc1
  v_add_u32 v3, 4096, v3
  s_waitcnt lgkmcnt(0)
  buffer_store_dwordx4 v[64:67], v3, s[56:59], s6 offen sc1
  s_waitcnt vmcnt(0)
  s_barrier
  s_cmp_lt_u32 s7, 64
  s_cbranch_scc0 L_lnpub2_50
  s_lshl_b32 s6, s3, 2
  s_add_u32 s6, s6, 65536
  v_and_b32 v100, 7, v0
  v_mul_u32_u24 v100, 4096, v100
  v_mov_b32 v101, s46
  s_mov_b64 s[86:87], exec
  s_mov_b64 exec, 0xff
  buffer_store_dword v101, v100, s[80:83], s6 offen sc1
  s_mov_b64 exec, s[86:87]
L_lnpub2_50:
  s_endpgm
L_code_end:
  s_endpgm
.section .rodata,"a"
.p2align 6
.amdhsa_kernel parallel_sum__ssm_conv_s4__dense_activation_relu__prompt_kernel
  .amdhsa_next_free_vgpr 128
  .amdhsa_next_free_sgpr 96
  .amdhsa_accum_offset 128
  .amdhsa_group_segment_fixed_size 0
  .amdhsa_kernarg_size 120
  .amdhsa_user_sgpr_count 2
  .amdhsa_user_sgpr_kernarg_segment_ptr 1
  .amdhsa_system_sgpr_workgroup_id_x 1
.end_amdhsa_kernel
```
